```python
import torch

def _softmax(x, axis=-1):
    return torch.softmax(x, dim=axis)
def _gelu(x):
    return torch.nn.functional.gelu(x, approximate="tanh")
def _silu(x):
    return torch.nn.functional.silu(x)
def _sigmoid(x):
    return torch.sigmoid(x)
def _layernorm(x, axis=-1, eps=1e-5):
    m = x.mean(dim=axis, keepdim=True)
    v = x.var(dim=axis, keepdim=True, unbiased=False)
    return (x - m) / torch.sqrt(v + eps)
def _scatter_add(tgt, idx, src, axis=0):
    return tgt.clone().index_add_(axis, idx, src)
def _segment_sum(src, seg, n):
    out = torch.zeros((n,) + src.shape[1:], dtype=src.dtype)
    return out.index_add_(0, seg, src)
def _pad(x, pw):
    flat = tuple(v for pair in reversed(pw) for v in pair)
    return torch.nn.functional.pad(x, flat)

kernel_name = 'standalone__mha_block_cached__near_ridge'

def setup_inputs():

    _w = (lambda a: (lambda t: t.to(torch.bfloat16) if t.is_floating_point() else t)(torch.as_tensor(a)))
    B, Sq, D = 8, 224, 512
    H, Sk, Dh = 32, 1024, 128
    return {
        "x": _w((lambda *s: torch.randn(*s, dtype=torch.bfloat16) * 0.8)(B, Sq, D)),
        "k_cache": _w((lambda *s: torch.randn(*s, dtype=torch.bfloat16) * 0.8)(B, H, Sk, Dh)),
        "v_cache": _w((lambda *s: torch.randn(*s, dtype=torch.bfloat16) * 0.05)(B, H, Sk, Dh)),
        "wq": _w((lambda *s: torch.randn(*s, dtype=torch.bfloat16) * 0.8)(D, H * Dh) * (D ** -0.5)),
        "wo": _w((lambda *s: torch.randn(*s, dtype=torch.bfloat16) * 0.05)(H * Dh, D) * ((H * Dh) ** -0.5)),
    }

def reference(x, k_cache, v_cache, wq, wo):
    B, Sq, D = x.shape
    H, Dh = 32, 128
    q = (lambda x, *d: x.permute(*d))((x @ wq).reshape(B, Sq, H, Dh), 0, 2, 1, 3)
    scores = torch.einsum("bhqd,bhkd->bhqk", q, k_cache) * (Dh ** -0.5)
    p = _softmax(scores, axis=-1)
    o = torch.einsum("bhqk,bhkd->bhqd", p, v_cache)
    return (lambda x, *d: x.permute(*d))(o, 0, 2, 1, 3).reshape(B, Sq, H * Dh) @ wo
```

```asm
; @launch kernel=attn_kernel grid=(256,1,1) block=(512,1,1) lds=155904
; @launch kernel=standalone__mha_block_cached__near_ridge_kernel grid=(224,1,1) block=(512,1,1) lds=131072
.amdgcn_target "amdgcn-amd-amdhsa--gfx950"
.text
.globl attn_kernel
.p2align 8
.type attn_kernel,@function
attn_kernel:
    s_cmp_ge_u32 s2, 256
    s_cbranch_scc1 L1_done
    s_load_dwordx4 s[4:7], s[0:1], 0
    s_load_dwordx4 s[8:11], s[0:1], 16
    s_load_dwordx2 s[12:13], s[0:1], 32
    s_load_dwordx2 s[14:15], s[0:1], 56
    v_lshrrev_b32 v1, 6, v0
    v_and_b32 v2, 63, v0
    v_readfirstlane_b32 s46, v1
    s_lshr_b32 s44, s2, 5
    s_and_b32 s45, s2, 31
    s_waitcnt lgkmcnt(0)
    s_cmp_eq_u32 s46, 7
    s_cbranch_scc1 L1_producer
    s_mul_i32 s51, s44, 229376
    s_lshl_b32 s52, s46, 15
    s_add_u32 s51, s51, s52
    s_add_u32 s28, s4, s51
    s_addc_u32 s29, s5, 0
    s_and_b32 s29, s29, 0xffff
    s_mov_b32 s30, 32768
    s_mov_b32 s31, 0x00020000
    s_lshl_b32 s57, s46, 13
    s_add_u32 s57, s57, 49152
    v_lshrrev_b32 v5, 4, v2
    v_and_b32 v6, 7, v2
    v_xor_b32 v6, v6, v5
    v_lshlrev_b32 v6, 4, v6
    v_lshrrev_b32 v5, 3, v2
    v_lshl_add_u32 v164, v5, 10, v6
    v_xor_b32 v165, 64, v164
    s_add_u32 m0, s57, 0
    s_mov_b32 s56, 0
    buffer_load_dwordx4 v164, s[28:31], s56 offen lds
    s_add_u32 m0, s57, 1024
    s_mov_b32 s56, 8192
    buffer_load_dwordx4 v165, s[28:31], s56 offen lds
    s_add_u32 m0, s57, 2048
    s_mov_b32 s56, 16384
    buffer_load_dwordx4 v164, s[28:31], s56 offen lds
    s_add_u32 m0, s57, 3072
    s_mov_b32 s56, 24576
    buffer_load_dwordx4 v165, s[28:31], s56 offen lds
    s_add_u32 m0, s57, 4096
    s_mov_b32 s56, 128
    buffer_load_dwordx4 v164, s[28:31], s56 offen lds
    s_add_u32 m0, s57, 5120
    s_mov_b32 s56, 8320
    buffer_load_dwordx4 v165, s[28:31], s56 offen lds
    s_add_u32 m0, s57, 6144
    s_mov_b32 s56, 16512
    buffer_load_dwordx4 v164, s[28:31], s56 offen lds
    s_add_u32 m0, s57, 7168
    s_mov_b32 s56, 24704
    buffer_load_dwordx4 v165, s[28:31], s56 offen lds
    s_mul_i32 s51, s44, 7
    s_add_u32 s51, s51, s46
    s_lshl_b32 s51, s51, 18
    s_lshl_b32 s52, s45, 13
    s_add_u32 s51, s51, s52
    s_add_u32 s32, s14, s51
    s_addc_u32 s33, s15, 0
    s_and_b32 s33, s33, 0xffff
    s_mov_b32 s34, 8192
    s_mov_b32 s35, 0x00020000
    v_mov_b32 v3, 155648
    s_lshl_b32 s51, s46, 2
    s_add_u32 s51, s51, 155680
    v_mov_b32 v10, s51
    v_xor_b32 v11, 16, v10
    s_mov_b32 s54, 0x3e0293ee
    s_mov_b32 s55, 0x41000000
    v_and_b32 v5, 31, v2
    v_lshrrev_b32 v6, 5, v2
    v_bfe_u32 v7, v2, 1, 3
    v_xor_b32 v7, v7, v6
    v_lshlrev_b32 v7, 4, v7
    v_lshl_add_u32 v7, v5, 7, v7
    v_add_u32 v160, s57, v7
    v_xor_b32 v161, 32, v160
    v_xor_b32 v162, 64, v160
    v_xor_b32 v163, 96, v160
    v_and_b32 v7, 15, v2
    v_xor_b32 v8, v6, v7
    v_lshlrev_b32 v8, 4, v8
    v_lshl_add_u32 v16, v5, 8, v8
    v_xor_b32 v17, 32, v16
    v_xor_b32 v18, 64, v16
    v_xor_b32 v19, 96, v16
    v_xor_b32 v20, 128, v16
    v_xor_b32 v21, 160, v16
    v_xor_b32 v22, 192, v16
    v_xor_b32 v23, 224, v16
    v_lshrrev_b32 v8, 2, v7
    v_bfe_u32 v9, v2, 4, 1
    v_bfe_u32 v32, v2, 1, 1
    v_lshl_add_u32 v32, v9, 1, v32
    v_lshlrev_b32 v32, 4, v32
    v_and_b32 v33, 1, v2
    v_lshl_add_u32 v32, v33, 3, v32
    v_lshl_add_u32 v32, v8, 6, v32
    v_lshl_add_u32 v33, v6, 2, v8
    v_lshl_add_u32 v32, v33, 8, v32
    v_add_u32 v24, 8192, v32
    v_xor_b32 v25, 64, v24
    v_xor_b32 v26, 128, v24
    v_xor_b32 v27, 192, v24
    v_and_b32 v32, 1, v2
    v_lshl_add_u32 v32, v9, 1, v32
    v_lshlrev_b32 v32, 4, v32
    v_bfe_u32 v33, v2, 1, 1
    v_lshl_add_u32 v32, v33, 3, v32
    v_lshl_add_u32 v32, v8, 6, v32
    v_lshl_add_u32 v33, v6, 3, v8
    v_lshl_add_u32 v34, v33, 8, v32
    v_add_u32 v28, 106496, v34
    v_xor_b32 v29, 64, v28
    v_xor_b32 v30, 128, v28
    v_xor_b32 v31, 192, v28
    v_mov_b32 v64, 0
    v_mov_b32 v65, 0
    v_mov_b32 v66, 0
    v_mov_b32 v67, 0
    v_mov_b32 v68, 0
    v_mov_b32 v69, 0
    v_mov_b32 v70, 0
    v_mov_b32 v71, 0
    v_mov_b32 v72, 0
    v_mov_b32 v73, 0
    v_mov_b32 v74, 0
    v_mov_b32 v75, 0
    v_mov_b32 v76, 0
    v_mov_b32 v77, 0
    v_mov_b32 v78, 0
    v_mov_b32 v79, 0
    v_mov_b32 v80, 0
    v_mov_b32 v81, 0
    v_mov_b32 v82, 0
    v_mov_b32 v83, 0
    v_mov_b32 v84, 0
    v_mov_b32 v85, 0
    v_mov_b32 v86, 0
    v_mov_b32 v87, 0
    v_mov_b32 v88, 0
    v_mov_b32 v89, 0
    v_mov_b32 v90, 0
    v_mov_b32 v91, 0
    v_mov_b32 v92, 0
    v_mov_b32 v93, 0
    v_mov_b32 v94, 0
    v_mov_b32 v95, 0
    v_mov_b32 v96, 0
    v_mov_b32 v97, 0
    v_mov_b32 v98, 0
    v_mov_b32 v99, 0
    v_mov_b32 v100, 0
    v_mov_b32 v101, 0
    v_mov_b32 v102, 0
    v_mov_b32 v103, 0
    v_mov_b32 v104, 0
    v_mov_b32 v105, 0
    v_mov_b32 v106, 0
    v_mov_b32 v107, 0
    v_mov_b32 v108, 0
    v_mov_b32 v109, 0
    v_mov_b32 v110, 0
    v_mov_b32 v111, 0
    v_mov_b32 v112, 0
    v_mov_b32 v113, 0
    v_mov_b32 v114, 0
    v_mov_b32 v115, 0
    v_mov_b32 v116, 0
    v_mov_b32 v117, 0
    v_mov_b32 v118, 0
    v_mov_b32 v119, 0
    v_mov_b32 v120, 0
    v_mov_b32 v121, 0
    v_mov_b32 v122, 0
    v_mov_b32 v123, 0
    v_mov_b32 v124, 0
    v_mov_b32 v125, 0
    v_mov_b32 v126, 0
    v_mov_b32 v127, 0
    s_mov_b32 s48, 0
    s_barrier
    s_waitcnt vmcnt(4)
    ds_read_b128 v[128:131], v160 offset:0
    ds_read_b128 v[132:135], v161 offset:0
    ds_read_b128 v[136:139], v162 offset:0
    ds_read_b128 v[140:143], v163 offset:0
    s_cmp_ge_u32 s48, 1
    s_cbranch_scc1 L_lok_1
L_lpoll_2:
    ds_read_b32 v4, v3 offset:0
    s_waitcnt lgkmcnt(0)
    v_readfirstlane_b32 s48, v4
    s_cmp_ge_u32 s48, 1
    s_cbranch_scc1 L_lok_1
    s_sleep 1
    s_branch L_lpoll_2
L_lok_1:
    ds_read_b64_tr_b16 v[32:33], v28 offset:0
    ds_read_b64_tr_b16 v[34:35], v28 offset:1024
    ds_read_b64_tr_b16 v[36:37], v29 offset:0
    ds_read_b64_tr_b16 v[38:39], v29 offset:1024
    ds_read_b64_tr_b16 v[40:41], v30 offset:0
    ds_read_b64_tr_b16 v[42:43], v30 offset:1024
    ds_read_b64_tr_b16 v[44:45], v31 offset:0
    ds_read_b64_tr_b16 v[46:47], v31 offset:1024
    ds_read_b64_tr_b16 v[48:49], v28 offset:4096
    ds_read_b64_tr_b16 v[50:51], v28 offset:5120
    ds_read_b64_tr_b16 v[52:53], v29 offset:4096
    ds_read_b64_tr_b16 v[54:55], v29 offset:5120
    ds_read_b64_tr_b16 v[56:57], v30 offset:4096
    ds_read_b64_tr_b16 v[58:59], v30 offset:5120
    ds_read_b64_tr_b16 v[60:61], v31 offset:4096
    ds_read_b64_tr_b16 v[62:63], v31 offset:5120
    v_mov_b32 v5, 1
    s_mov_b64 exec, 1
    ds_write_b32 v10, v5
    s_mov_b64 exec, -1
    s_waitcnt lgkmcnt(9)
    v_mfma_f32_32x32x16_bf16 v[64:79], v[32:35], v[128:131], v[64:79]
    v_mfma_f32_32x32x16_bf16 v[80:95], v[36:39], v[128:131], v[80:95]
    v_mfma_f32_32x32x16_bf16 v[96:111], v[40:43], v[128:131], v[96:111]
    v_mfma_f32_32x32x16_bf16 v[112:127], v[44:47], v[128:131], v[112:127]
    s_add_u32 m0, s57, 0
    s_mov_b32 s56, 256
    buffer_load_dwordx4 v164, s[28:31], s56 offen lds
    s_add_u32 m0, s57, 1024
    s_mov_b32 s56, 8448
    buffer_load_dwordx4 v165, s[28:31], s56 offen lds
    s_add_u32 m0, s57, 2048
    s_mov_b32 s56, 16640
    buffer_load_dwordx4 v164, s[28:31], s56 offen lds
    s_add_u32 m0, s57, 3072
    s_mov_b32 s56, 24832
    buffer_load_dwordx4 v165, s[28:31], s56 offen lds
    s_cmp_ge_u32 s48, 2
    s_cbranch_scc1 L_lok_3
L_lpoll_4:
    ds_read_b32 v4, v3 offset:0
    s_waitcnt lgkmcnt(0)
    v_readfirstlane_b32 s48, v4
    s_cmp_ge_u32 s48, 2
    s_cbranch_scc1 L_lok_3
    s_sleep 1
    s_branch L_lpoll_4
L_lok_3:
    ds_read_b64_tr_b16 v[32:33], v28 offset:8192
    ds_read_b64_tr_b16 v[34:35], v28 offset:9216
    ds_read_b64_tr_b16 v[36:37], v29 offset:8192
    ds_read_b64_tr_b16 v[38:39], v29 offset:9216
    ds_read_b64_tr_b16 v[40:41], v30 offset:8192
    ds_read_b64_tr_b16 v[42:43], v30 offset:9216
    ds_read_b64_tr_b16 v[44:45], v31 offset:8192
    ds_read_b64_tr_b16 v[46:47], v31 offset:9216
    s_waitcnt lgkmcnt(8)
    v_mfma_f32_32x32x16_bf16 v[64:79], v[48:51], v[132:135], v[64:79]
    v_mfma_f32_32x32x16_bf16 v[80:95], v[52:55], v[132:135], v[80:95]
    v_mfma_f32_32x32x16_bf16 v[96:111], v[56:59], v[132:135], v[96:111]
    v_mfma_f32_32x32x16_bf16 v[112:127], v[60:63], v[132:135], v[112:127]
    ds_read_b64_tr_b16 v[48:49], v28 offset:12288
    ds_read_b64_tr_b16 v[50:51], v28 offset:13312
    ds_read_b64_tr_b16 v[52:53], v29 offset:12288
    ds_read_b64_tr_b16 v[54:55], v29 offset:13312
    ds_read_b64_tr_b16 v[56:57], v30 offset:12288
    ds_read_b64_tr_b16 v[58:59], v30 offset:13312
    ds_read_b64_tr_b16 v[60:61], v31 offset:12288
    ds_read_b64_tr_b16 v[62:63], v31 offset:13312
    v_mov_b32 v5, 2
    s_mov_b64 exec, 1
    ds_write_b32 v10, v5
    s_mov_b64 exec, -1
    s_waitcnt lgkmcnt(9)
    v_mfma_f32_32x32x16_bf16 v[64:79], v[32:35], v[136:139], v[64:79]
    v_mfma_f32_32x32x16_bf16 v[80:95], v[36:39], v[136:139], v[80:95]
    v_mfma_f32_32x32x16_bf16 v[96:111], v[40:43], v[136:139], v[96:111]
    v_mfma_f32_32x32x16_bf16 v[112:127], v[44:47], v[136:139], v[112:127]
    s_waitcnt vmcnt(4)
    ds_read_b128 v[144:147], v160 offset:4096
    ds_read_b128 v[148:151], v161 offset:4096
    ds_read_b128 v[152:155], v162 offset:4096
    ds_read_b128 v[156:159], v163 offset:4096
    s_cmp_ge_u32 s48, 3
    s_cbranch_scc1 L_lok_5
L_lpoll_6:
    ds_read_b32 v4, v3 offset:0
    s_waitcnt lgkmcnt(0)
    v_readfirstlane_b32 s48, v4
    s_cmp_ge_u32 s48, 3
    s_cbranch_scc1 L_lok_5
    s_sleep 1
    s_branch L_lpoll_6
L_lok_5:
    ds_read_b64_tr_b16 v[32:33], v28 offset:16384
    ds_read_b64_tr_b16 v[34:35], v28 offset:17408
    ds_read_b64_tr_b16 v[36:37], v29 offset:16384
    ds_read_b64_tr_b16 v[38:39], v29 offset:17408
    ds_read_b64_tr_b16 v[40:41], v30 offset:16384
    ds_read_b64_tr_b16 v[42:43], v30 offset:17408
    ds_read_b64_tr_b16 v[44:45], v31 offset:16384
    ds_read_b64_tr_b16 v[46:47], v31 offset:17408
    s_waitcnt lgkmcnt(12)
    v_mfma_f32_32x32x16_bf16 v[64:79], v[48:51], v[140:143], v[64:79]
    v_mfma_f32_32x32x16_bf16 v[80:95], v[52:55], v[140:143], v[80:95]
    v_mfma_f32_32x32x16_bf16 v[96:111], v[56:59], v[140:143], v[96:111]
    v_mfma_f32_32x32x16_bf16 v[112:127], v[60:63], v[140:143], v[112:127]
    ds_read_b64_tr_b16 v[48:49], v28 offset:20480
    ds_read_b64_tr_b16 v[50:51], v28 offset:21504
    ds_read_b64_tr_b16 v[52:53], v29 offset:20480
    ds_read_b64_tr_b16 v[54:55], v29 offset:21504
    ds_read_b64_tr_b16 v[56:57], v30 offset:20480
    ds_read_b64_tr_b16 v[58:59], v30 offset:21504
    ds_read_b64_tr_b16 v[60:61], v31 offset:20480
    ds_read_b64_tr_b16 v[62:63], v31 offset:21504
    v_mov_b32 v5, 3
    s_mov_b64 exec, 1
    ds_write_b32 v10, v5
    s_mov_b64 exec, -1
    s_waitcnt lgkmcnt(9)
    v_mfma_f32_32x32x16_bf16 v[64:79], v[32:35], v[144:147], v[64:79]
    v_mfma_f32_32x32x16_bf16 v[80:95], v[36:39], v[144:147], v[80:95]
    v_mfma_f32_32x32x16_bf16 v[96:111], v[40:43], v[144:147], v[96:111]
    v_mfma_f32_32x32x16_bf16 v[112:127], v[44:47], v[144:147], v[112:127]
    s_add_u32 m0, s57, 4096
    s_mov_b32 s56, 384
    buffer_load_dwordx4 v164, s[28:31], s56 offen lds
    s_add_u32 m0, s57, 5120
    s_mov_b32 s56, 8576
    buffer_load_dwordx4 v165, s[28:31], s56 offen lds
    s_add_u32 m0, s57, 6144
    s_mov_b32 s56, 16768
    buffer_load_dwordx4 v164, s[28:31], s56 offen lds
    s_add_u32 m0, s57, 7168
    s_mov_b32 s56, 24960
    buffer_load_dwordx4 v165, s[28:31], s56 offen lds
    s_cmp_ge_u32 s48, 4
    s_cbranch_scc1 L_lok_7
L_lpoll_8:
    ds_read_b32 v4, v3 offset:0
    s_waitcnt lgkmcnt(0)
    v_readfirstlane_b32 s48, v4
    s_cmp_ge_u32 s48, 4
    s_cbranch_scc1 L_lok_7
    s_sleep 1
    s_branch L_lpoll_8
L_lok_7:
    ds_read_b64_tr_b16 v[32:33], v28 offset:24576
    ds_read_b64_tr_b16 v[34:35], v28 offset:25600
    ds_read_b64_tr_b16 v[36:37], v29 offset:24576
    ds_read_b64_tr_b16 v[38:39], v29 offset:25600
    ds_read_b64_tr_b16 v[40:41], v30 offset:24576
    ds_read_b64_tr_b16 v[42:43], v30 offset:25600
    ds_read_b64_tr_b16 v[44:45], v31 offset:24576
    ds_read_b64_tr_b16 v[46:47], v31 offset:25600
    s_waitcnt lgkmcnt(8)
    v_mfma_f32_32x32x16_bf16 v[64:79], v[48:51], v[148:151], v[64:79]
    v_mfma_f32_32x32x16_bf16 v[80:95], v[52:55], v[148:151], v[80:95]
    v_mfma_f32_32x32x16_bf16 v[96:111], v[56:59], v[148:151], v[96:111]
    v_mfma_f32_32x32x16_bf16 v[112:127], v[60:63], v[148:151], v[112:127]
    ds_read_b64_tr_b16 v[48:49], v28 offset:28672
    ds_read_b64_tr_b16 v[50:51], v28 offset:29696
    ds_read_b64_tr_b16 v[52:53], v29 offset:28672
    ds_read_b64_tr_b16 v[54:55], v29 offset:29696
    ds_read_b64_tr_b16 v[56:57], v30 offset:28672
    ds_read_b64_tr_b16 v[58:59], v30 offset:29696
    ds_read_b64_tr_b16 v[60:61], v31 offset:28672
    ds_read_b64_tr_b16 v[62:63], v31 offset:29696
    v_mov_b32 v5, 4
    s_mov_b64 exec, 1
    ds_write_b32 v10, v5
    s_mov_b64 exec, -1
    s_waitcnt lgkmcnt(9)
    v_mfma_f32_32x32x16_bf16 v[64:79], v[32:35], v[152:155], v[64:79]
    v_mfma_f32_32x32x16_bf16 v[80:95], v[36:39], v[152:155], v[80:95]
    v_mfma_f32_32x32x16_bf16 v[96:111], v[40:43], v[152:155], v[96:111]
    v_mfma_f32_32x32x16_bf16 v[112:127], v[44:47], v[152:155], v[112:127]
    s_waitcnt vmcnt(4)
    ds_read_b128 v[128:131], v160 offset:0
    ds_read_b128 v[132:135], v161 offset:0
    ds_read_b128 v[136:139], v162 offset:0
    ds_read_b128 v[140:143], v163 offset:0
    s_cmp_ge_u32 s48, 5
    s_cbranch_scc1 L_lok_9
L_lpoll_10:
    ds_read_b32 v4, v3 offset:0
    s_waitcnt lgkmcnt(0)
    v_readfirstlane_b32 s48, v4
    s_cmp_ge_u32 s48, 5
    s_cbranch_scc1 L_lok_9
    s_sleep 1
    s_branch L_lpoll_10
L_lok_9:
    ds_read_b64_tr_b16 v[32:33], v28 offset:32768
    ds_read_b64_tr_b16 v[34:35], v28 offset:33792
    ds_read_b64_tr_b16 v[36:37], v29 offset:32768
    ds_read_b64_tr_b16 v[38:39], v29 offset:33792
    ds_read_b64_tr_b16 v[40:41], v30 offset:32768
    ds_read_b64_tr_b16 v[42:43], v30 offset:33792
    ds_read_b64_tr_b16 v[44:45], v31 offset:32768
    ds_read_b64_tr_b16 v[46:47], v31 offset:33792
    s_waitcnt lgkmcnt(12)
    v_mfma_f32_32x32x16_bf16 v[64:79], v[48:51], v[156:159], v[64:79]
    v_mfma_f32_32x32x16_bf16 v[80:95], v[52:55], v[156:159], v[80:95]
    v_mfma_f32_32x32x16_bf16 v[96:111], v[56:59], v[156:159], v[96:111]
    v_mfma_f32_32x32x16_bf16 v[112:127], v[60:63], v[156:159], v[112:127]
    ds_read_b64_tr_b16 v[48:49], v28 offset:36864
    ds_read_b64_tr_b16 v[50:51], v28 offset:37888
    ds_read_b64_tr_b16 v[52:53], v29 offset:36864
    ds_read_b64_tr_b16 v[54:55], v29 offset:37888
    ds_read_b64_tr_b16 v[56:57], v30 offset:36864
    ds_read_b64_tr_b16 v[58:59], v30 offset:37888
    ds_read_b64_tr_b16 v[60:61], v31 offset:36864
    ds_read_b64_tr_b16 v[62:63], v31 offset:37888
    v_mov_b32 v5, 5
    s_mov_b64 exec, 1
    ds_write_b32 v10, v5
    s_mov_b64 exec, -1
    s_waitcnt lgkmcnt(9)
    v_mfma_f32_32x32x16_bf16 v[64:79], v[32:35], v[128:131], v[64:79]
    v_mfma_f32_32x32x16_bf16 v[80:95], v[36:39], v[128:131], v[80:95]
    v_mfma_f32_32x32x16_bf16 v[96:111], v[40:43], v[128:131], v[96:111]
    v_mfma_f32_32x32x16_bf16 v[112:127], v[44:47], v[128:131], v[112:127]
    s_add_u32 m0, s57, 0
    s_mov_b32 s56, 512
    buffer_load_dwordx4 v164, s[28:31], s56 offen lds
    s_add_u32 m0, s57, 1024
    s_mov_b32 s56, 8704
    buffer_load_dwordx4 v165, s[28:31], s56 offen lds
    s_add_u32 m0, s57, 2048
    s_mov_b32 s56, 16896
    buffer_load_dwordx4 v164, s[28:31], s56 offen lds
    s_add_u32 m0, s57, 3072
    s_mov_b32 s56, 25088
    buffer_load_dwordx4 v165, s[28:31], s56 offen lds
    s_cmp_ge_u32 s48, 6
    s_cbranch_scc1 L_lok_11
L_lpoll_12:
    ds_read_b32 v4, v3 offset:0
    s_waitcnt lgkmcnt(0)
    v_readfirstlane_b32 s48, v4
    s_cmp_ge_u32 s48, 6
    s_cbranch_scc1 L_lok_11
    s_sleep 1
    s_branch L_lpoll_12
L_lok_11:
    ds_read_b64_tr_b16 v[32:33], v28 offset:40960
    ds_read_b64_tr_b16 v[34:35], v28 offset:41984
    ds_read_b64_tr_b16 v[36:37], v29 offset:40960
    ds_read_b64_tr_b16 v[38:39], v29 offset:41984
    ds_read_b64_tr_b16 v[40:41], v30 offset:40960
    ds_read_b64_tr_b16 v[42:43], v30 offset:41984
    ds_read_b64_tr_b16 v[44:45], v31 offset:40960
    ds_read_b64_tr_b16 v[46:47], v31 offset:41984
    s_waitcnt lgkmcnt(8)
    v_mfma_f32_32x32x16_bf16 v[64:79], v[48:51], v[132:135], v[64:79]
    v_mfma_f32_32x32x16_bf16 v[80:95], v[52:55], v[132:135], v[80:95]
    v_mfma_f32_32x32x16_bf16 v[96:111], v[56:59], v[132:135], v[96:111]
    v_mfma_f32_32x32x16_bf16 v[112:127], v[60:63], v[132:135], v[112:127]
    ds_read_b64_tr_b16 v[48:49], v28 offset:45056
    ds_read_b64_tr_b16 v[50:51], v28 offset:46080
    ds_read_b64_tr_b16 v[52:53], v29 offset:45056
    ds_read_b64_tr_b16 v[54:55], v29 offset:46080
    ds_read_b64_tr_b16 v[56:57], v30 offset:45056
    ds_read_b64_tr_b16 v[58:59], v30 offset:46080
    ds_read_b64_tr_b16 v[60:61], v31 offset:45056
    ds_read_b64_tr_b16 v[62:63], v31 offset:46080
    v_mov_b32 v5, 6
    s_mov_b64 exec, 1
    ds_write_b32 v10, v5
    s_mov_b64 exec, -1
    s_waitcnt lgkmcnt(9)
    v_mfma_f32_32x32x16_bf16 v[64:79], v[32:35], v[136:139], v[64:79]
    v_mfma_f32_32x32x16_bf16 v[80:95], v[36:39], v[136:139], v[80:95]
    v_mfma_f32_32x32x16_bf16 v[96:111], v[40:43], v[136:139], v[96:111]
    v_mfma_f32_32x32x16_bf16 v[112:127], v[44:47], v[136:139], v[112:127]
    s_waitcnt vmcnt(4)
    ds_read_b128 v[144:147], v160 offset:4096
    ds_read_b128 v[148:151], v161 offset:4096
    ds_read_b128 v[152:155], v162 offset:4096
    ds_read_b128 v[156:159], v163 offset:4096
    s_cmp_ge_u32 s48, 7
    s_cbranch_scc1 L_lok_13
L_lpoll_14:
    ds_read_b32 v4, v3 offset:0
    s_waitcnt lgkmcnt(0)
    v_readfirstlane_b32 s48, v4
    s_cmp_ge_u32 s48, 7
    s_cbranch_scc1 L_lok_13
    s_sleep 1
    s_branch L_lpoll_14
L_lok_13:
    ds_read_b64_tr_b16 v[32:33], v28 offset:0
    ds_read_b64_tr_b16 v[34:35], v28 offset:1024
    ds_read_b64_tr_b16 v[36:37], v29 offset:0
    ds_read_b64_tr_b16 v[38:39], v29 offset:1024
    ds_read_b64_tr_b16 v[40:41], v30 offset:0
    ds_read_b64_tr_b16 v[42:43], v30 offset:1024
    ds_read_b64_tr_b16 v[44:45], v31 offset:0
    ds_read_b64_tr_b16 v[46:47], v31 offset:1024
    s_waitcnt lgkmcnt(12)
    v_mfma_f32_32x32x16_bf16 v[64:79], v[48:51], v[140:143], v[64:79]
    v_mfma_f32_32x32x16_bf16 v[80:95], v[52:55], v[140:143], v[80:95]
    v_mfma_f32_32x32x16_bf16 v[96:111], v[56:59], v[140:143], v[96:111]
    v_mfma_f32_32x32x16_bf16 v[112:127], v[60:63], v[140:143], v[112:127]
    ds_read_b64_tr_b16 v[48:49], v28 offset:4096
    ds_read_b64_tr_b16 v[50:51], v28 offset:5120
    ds_read_b64_tr_b16 v[52:53], v29 offset:4096
    ds_read_b64_tr_b16 v[54:55], v29 offset:5120
    ds_read_b64_tr_b16 v[56:57], v30 offset:4096
    ds_read_b64_tr_b16 v[58:59], v30 offset:5120
    ds_read_b64_tr_b16 v[60:61], v31 offset:4096
    ds_read_b64_tr_b16 v[62:63], v31 offset:5120
    v_mov_b32 v5, 7
    s_mov_b64 exec, 1
    ds_write_b32 v10, v5
    s_mov_b64 exec, -1
    s_waitcnt lgkmcnt(9)
    v_mfma_f32_32x32x16_bf16 v[64:79], v[32:35], v[144:147], v[64:79]
    v_mfma_f32_32x32x16_bf16 v[80:95], v[36:39], v[144:147], v[80:95]
    v_mfma_f32_32x32x16_bf16 v[96:111], v[40:43], v[144:147], v[96:111]
    v_mfma_f32_32x32x16_bf16 v[112:127], v[44:47], v[144:147], v[112:127]
    s_add_u32 m0, s57, 4096
    s_mov_b32 s56, 640
    buffer_load_dwordx4 v164, s[28:31], s56 offen lds
    s_add_u32 m0, s57, 5120
    s_mov_b32 s56, 8832
    buffer_load_dwordx4 v165, s[28:31], s56 offen lds
    s_add_u32 m0, s57, 6144
    s_mov_b32 s56, 17024
    buffer_load_dwordx4 v164, s[28:31], s56 offen lds
    s_add_u32 m0, s57, 7168
    s_mov_b32 s56, 25216
    buffer_load_dwordx4 v165, s[28:31], s56 offen lds
    s_cmp_ge_u32 s48, 8
    s_cbranch_scc1 L_lok_15
L_lpoll_16:
    ds_read_b32 v4, v3 offset:0
    s_waitcnt lgkmcnt(0)
    v_readfirstlane_b32 s48, v4
    s_cmp_ge_u32 s48, 8
    s_cbranch_scc1 L_lok_15
    s_sleep 1
    s_branch L_lpoll_16
L_lok_15:
    ds_read_b64_tr_b16 v[32:33], v28 offset:8192
    ds_read_b64_tr_b16 v[34:35], v28 offset:9216
    ds_read_b64_tr_b16 v[36:37], v29 offset:8192
    ds_read_b64_tr_b16 v[38:39], v29 offset:9216
    ds_read_b64_tr_b16 v[40:41], v30 offset:8192
    ds_read_b64_tr_b16 v[42:43], v30 offset:9216
    ds_read_b64_tr_b16 v[44:45], v31 offset:8192
    ds_read_b64_tr_b16 v[46:47], v31 offset:9216
    s_waitcnt lgkmcnt(8)
    v_mfma_f32_32x32x16_bf16 v[64:79], v[48:51], v[148:151], v[64:79]
    v_mfma_f32_32x32x16_bf16 v[80:95], v[52:55], v[148:151], v[80:95]
    v_mfma_f32_32x32x16_bf16 v[96:111], v[56:59], v[148:151], v[96:111]
    v_mfma_f32_32x32x16_bf16 v[112:127], v[60:63], v[148:151], v[112:127]
    ds_read_b64_tr_b16 v[48:49], v28 offset:12288
    ds_read_b64_tr_b16 v[50:51], v28 offset:13312
    ds_read_b64_tr_b16 v[52:53], v29 offset:12288
    ds_read_b64_tr_b16 v[54:55], v29 offset:13312
    ds_read_b64_tr_b16 v[56:57], v30 offset:12288
    ds_read_b64_tr_b16 v[58:59], v30 offset:13312
    ds_read_b64_tr_b16 v[60:61], v31 offset:12288
    ds_read_b64_tr_b16 v[62:63], v31 offset:13312
    v_mov_b32 v5, 8
    s_mov_b64 exec, 1
    ds_write_b32 v10, v5
    s_mov_b64 exec, -1
    s_waitcnt lgkmcnt(9)
    v_mfma_f32_32x32x16_bf16 v[64:79], v[32:35], v[152:155], v[64:79]
    v_mfma_f32_32x32x16_bf16 v[80:95], v[36:39], v[152:155], v[80:95]
    v_mfma_f32_32x32x16_bf16 v[96:111], v[40:43], v[152:155], v[96:111]
    v_mfma_f32_32x32x16_bf16 v[112:127], v[44:47], v[152:155], v[112:127]
    s_waitcnt vmcnt(4)
    ds_read_b128 v[128:131], v160 offset:0
    ds_read_b128 v[132:135], v161 offset:0
    ds_read_b128 v[136:139], v162 offset:0
    ds_read_b128 v[140:143], v163 offset:0
    s_cmp_ge_u32 s48, 9
    s_cbranch_scc1 L_lok_17
L_lpoll_18:
    ds_read_b32 v4, v3 offset:0
    s_waitcnt lgkmcnt(0)
    v_readfirstlane_b32 s48, v4
    s_cmp_ge_u32 s48, 9
    s_cbranch_scc1 L_lok_17
    s_sleep 1
    s_branch L_lpoll_18
L_lok_17:
    ds_read_b64_tr_b16 v[32:33], v28 offset:16384
    ds_read_b64_tr_b16 v[34:35], v28 offset:17408
    ds_read_b64_tr_b16 v[36:37], v29 offset:16384
    ds_read_b64_tr_b16 v[38:39], v29 offset:17408
    ds_read_b64_tr_b16 v[40:41], v30 offset:16384
    ds_read_b64_tr_b16 v[42:43], v30 offset:17408
    ds_read_b64_tr_b16 v[44:45], v31 offset:16384
    ds_read_b64_tr_b16 v[46:47], v31 offset:17408
    s_waitcnt lgkmcnt(12)
    v_mfma_f32_32x32x16_bf16 v[64:79], v[48:51], v[156:159], v[64:79]
    v_mfma_f32_32x32x16_bf16 v[80:95], v[52:55], v[156:159], v[80:95]
    v_mfma_f32_32x32x16_bf16 v[96:111], v[56:59], v[156:159], v[96:111]
    v_mfma_f32_32x32x16_bf16 v[112:127], v[60:63], v[156:159], v[112:127]
    ds_read_b64_tr_b16 v[48:49], v28 offset:20480
    ds_read_b64_tr_b16 v[50:51], v28 offset:21504
    ds_read_b64_tr_b16 v[52:53], v29 offset:20480
    ds_read_b64_tr_b16 v[54:55], v29 offset:21504
    ds_read_b64_tr_b16 v[56:57], v30 offset:20480
    ds_read_b64_tr_b16 v[58:59], v30 offset:21504
    ds_read_b64_tr_b16 v[60:61], v31 offset:20480
    ds_read_b64_tr_b16 v[62:63], v31 offset:21504
    v_mov_b32 v5, 9
    s_mov_b64 exec, 1
    ds_write_b32 v10, v5
    s_mov_b64 exec, -1
    s_waitcnt lgkmcnt(9)
    v_mfma_f32_32x32x16_bf16 v[64:79], v[32:35], v[128:131], v[64:79]
    v_mfma_f32_32x32x16_bf16 v[80:95], v[36:39], v[128:131], v[80:95]
    v_mfma_f32_32x32x16_bf16 v[96:111], v[40:43], v[128:131], v[96:111]
    v_mfma_f32_32x32x16_bf16 v[112:127], v[44:47], v[128:131], v[112:127]
    s_add_u32 m0, s57, 0
    s_mov_b32 s56, 768
    buffer_load_dwordx4 v164, s[28:31], s56 offen lds
    s_add_u32 m0, s57, 1024
    s_mov_b32 s56, 8960
    buffer_load_dwordx4 v165, s[28:31], s56 offen lds
    s_add_u32 m0, s57, 2048
    s_mov_b32 s56, 17152
    buffer_load_dwordx4 v164, s[28:31], s56 offen lds
    s_add_u32 m0, s57, 3072
    s_mov_b32 s56, 25344
    buffer_load_dwordx4 v165, s[28:31], s56 offen lds
    s_cmp_ge_u32 s48, 10
    s_cbranch_scc1 L_lok_19
L_lpoll_20:
    ds_read_b32 v4, v3 offset:0
    s_waitcnt lgkmcnt(0)
    v_readfirstlane_b32 s48, v4
    s_cmp_ge_u32 s48, 10
    s_cbranch_scc1 L_lok_19
    s_sleep 1
    s_branch L_lpoll_20
L_lok_19:
    ds_read_b64_tr_b16 v[32:33], v28 offset:24576
    ds_read_b64_tr_b16 v[34:35], v28 offset:25600
    ds_read_b64_tr_b16 v[36:37], v29 offset:24576
    ds_read_b64_tr_b16 v[38:39], v29 offset:25600
    ds_read_b64_tr_b16 v[40:41], v30 offset:24576
    ds_read_b64_tr_b16 v[42:43], v30 offset:25600
    ds_read_b64_tr_b16 v[44:45], v31 offset:24576
    ds_read_b64_tr_b16 v[46:47], v31 offset:25600
    s_waitcnt lgkmcnt(8)
    v_mfma_f32_32x32x16_bf16 v[64:79], v[48:51], v[132:135], v[64:79]
    v_mfma_f32_32x32x16_bf16 v[80:95], v[52:55], v[132:135], v[80:95]
    v_mfma_f32_32x32x16_bf16 v[96:111], v[56:59], v[132:135], v[96:111]
    v_mfma_f32_32x32x16_bf16 v[112:127], v[60:63], v[132:135], v[112:127]
    ds_read_b64_tr_b16 v[48:49], v28 offset:28672
    ds_read_b64_tr_b16 v[50:51], v28 offset:29696
    ds_read_b64_tr_b16 v[52:53], v29 offset:28672
    ds_read_b64_tr_b16 v[54:55], v29 offset:29696
    ds_read_b64_tr_b16 v[56:57], v30 offset:28672
    ds_read_b64_tr_b16 v[58:59], v30 offset:29696
    ds_read_b64_tr_b16 v[60:61], v31 offset:28672
    ds_read_b64_tr_b16 v[62:63], v31 offset:29696
    v_mov_b32 v5, 10
    s_mov_b64 exec, 1
    ds_write_b32 v10, v5
    s_mov_b64 exec, -1
    s_waitcnt lgkmcnt(9)
    v_mfma_f32_32x32x16_bf16 v[64:79], v[32:35], v[136:139], v[64:79]
    v_mfma_f32_32x32x16_bf16 v[80:95], v[36:39], v[136:139], v[80:95]
    v_mfma_f32_32x32x16_bf16 v[96:111], v[40:43], v[136:139], v[96:111]
    v_mfma_f32_32x32x16_bf16 v[112:127], v[44:47], v[136:139], v[112:127]
    s_waitcnt vmcnt(4)
    ds_read_b128 v[144:147], v160 offset:4096
    ds_read_b128 v[148:151], v161 offset:4096
    ds_read_b128 v[152:155], v162 offset:4096
    ds_read_b128 v[156:159], v163 offset:4096
    s_cmp_ge_u32 s48, 11
    s_cbranch_scc1 L_lok_21
L_lpoll_22:
    ds_read_b32 v4, v3 offset:0
    s_waitcnt lgkmcnt(0)
    v_readfirstlane_b32 s48, v4
    s_cmp_ge_u32 s48, 11
    s_cbranch_scc1 L_lok_21
    s_sleep 1
    s_branch L_lpoll_22
L_lok_21:
    ds_read_b64_tr_b16 v[32:33], v28 offset:32768
    ds_read_b64_tr_b16 v[34:35], v28 offset:33792
    ds_read_b64_tr_b16 v[36:37], v29 offset:32768
    ds_read_b64_tr_b16 v[38:39], v29 offset:33792
    ds_read_b64_tr_b16 v[40:41], v30 offset:32768
    ds_read_b64_tr_b16 v[42:43], v30 offset:33792
    ds_read_b64_tr_b16 v[44:45], v31 offset:32768
    ds_read_b64_tr_b16 v[46:47], v31 offset:33792
    s_waitcnt lgkmcnt(12)
    v_mfma_f32_32x32x16_bf16 v[64:79], v[48:51], v[140:143], v[64:79]
    v_mfma_f32_32x32x16_bf16 v[80:95], v[52:55], v[140:143], v[80:95]
    v_mfma_f32_32x32x16_bf16 v[96:111], v[56:59], v[140:143], v[96:111]
    v_mfma_f32_32x32x16_bf16 v[112:127], v[60:63], v[140:143], v[112:127]
    ds_read_b64_tr_b16 v[48:49], v28 offset:36864
    ds_read_b64_tr_b16 v[50:51], v28 offset:37888
    ds_read_b64_tr_b16 v[52:53], v29 offset:36864
    ds_read_b64_tr_b16 v[54:55], v29 offset:37888
    ds_read_b64_tr_b16 v[56:57], v30 offset:36864
    ds_read_b64_tr_b16 v[58:59], v30 offset:37888
    ds_read_b64_tr_b16 v[60:61], v31 offset:36864
    ds_read_b64_tr_b16 v[62:63], v31 offset:37888
    v_mov_b32 v5, 11
    s_mov_b64 exec, 1
    ds_write_b32 v10, v5
    s_mov_b64 exec, -1
    s_waitcnt lgkmcnt(9)
    v_mfma_f32_32x32x16_bf16 v[64:79], v[32:35], v[144:147], v[64:79]
    v_mfma_f32_32x32x16_bf16 v[80:95], v[36:39], v[144:147], v[80:95]
    v_mfma_f32_32x32x16_bf16 v[96:111], v[40:43], v[144:147], v[96:111]
    v_mfma_f32_32x32x16_bf16 v[112:127], v[44:47], v[144:147], v[112:127]
    s_add_u32 m0, s57, 4096
    s_mov_b32 s56, 896
    buffer_load_dwordx4 v164, s[28:31], s56 offen lds
    s_add_u32 m0, s57, 5120
    s_mov_b32 s56, 9088
    buffer_load_dwordx4 v165, s[28:31], s56 offen lds
    s_add_u32 m0, s57, 6144
    s_mov_b32 s56, 17280
    buffer_load_dwordx4 v164, s[28:31], s56 offen lds
    s_add_u32 m0, s57, 7168
    s_mov_b32 s56, 25472
    buffer_load_dwordx4 v165, s[28:31], s56 offen lds
    s_cmp_ge_u32 s48, 12
    s_cbranch_scc1 L_lok_23
L_lpoll_24:
    ds_read_b32 v4, v3 offset:0
    s_waitcnt lgkmcnt(0)
    v_readfirstlane_b32 s48, v4
    s_cmp_ge_u32 s48, 12
    s_cbranch_scc1 L_lok_23
    s_sleep 1
    s_branch L_lpoll_24
L_lok_23:
    ds_read_b64_tr_b16 v[32:33], v28 offset:40960
    ds_read_b64_tr_b16 v[34:35], v28 offset:41984
    ds_read_b64_tr_b16 v[36:37], v29 offset:40960
    ds_read_b64_tr_b16 v[38:39], v29 offset:41984
    ds_read_b64_tr_b16 v[40:41], v30 offset:40960
    ds_read_b64_tr_b16 v[42:43], v30 offset:41984
    ds_read_b64_tr_b16 v[44:45], v31 offset:40960
    ds_read_b64_tr_b16 v[46:47], v31 offset:41984
    s_waitcnt lgkmcnt(8)
    v_mfma_f32_32x32x16_bf16 v[64:79], v[48:51], v[148:151], v[64:79]
    v_mfma_f32_32x32x16_bf16 v[80:95], v[52:55], v[148:151], v[80:95]
    v_mfma_f32_32x32x16_bf16 v[96:111], v[56:59], v[148:151], v[96:111]
    v_mfma_f32_32x32x16_bf16 v[112:127], v[60:63], v[148:151], v[112:127]
    ds_read_b64_tr_b16 v[48:49], v28 offset:45056
    ds_read_b64_tr_b16 v[50:51], v28 offset:46080
    ds_read_b64_tr_b16 v[52:53], v29 offset:45056
    ds_read_b64_tr_b16 v[54:55], v29 offset:46080
    ds_read_b64_tr_b16 v[56:57], v30 offset:45056
    ds_read_b64_tr_b16 v[58:59], v30 offset:46080
    ds_read_b64_tr_b16 v[60:61], v31 offset:45056
    ds_read_b64_tr_b16 v[62:63], v31 offset:46080
    v_mov_b32 v5, 12
    s_mov_b64 exec, 1
    ds_write_b32 v10, v5
    s_mov_b64 exec, -1
    s_waitcnt lgkmcnt(9)
    v_mfma_f32_32x32x16_bf16 v[64:79], v[32:35], v[152:155], v[64:79]
    v_mfma_f32_32x32x16_bf16 v[80:95], v[36:39], v[152:155], v[80:95]
    v_mfma_f32_32x32x16_bf16 v[96:111], v[40:43], v[152:155], v[96:111]
    v_mfma_f32_32x32x16_bf16 v[112:127], v[44:47], v[152:155], v[112:127]
    s_waitcnt vmcnt(4)
    ds_read_b128 v[128:131], v160 offset:0
    ds_read_b128 v[132:135], v161 offset:0
    ds_read_b128 v[136:139], v162 offset:0
    ds_read_b128 v[140:143], v163 offset:0
    s_cmp_ge_u32 s48, 13
    s_cbranch_scc1 L_lok_25
L_lpoll_26:
    ds_read_b32 v4, v3 offset:0
    s_waitcnt lgkmcnt(0)
    v_readfirstlane_b32 s48, v4
    s_cmp_ge_u32 s48, 13
    s_cbranch_scc1 L_lok_25
    s_sleep 1
    s_branch L_lpoll_26
L_lok_25:
    ds_read_b64_tr_b16 v[32:33], v28 offset:0
    ds_read_b64_tr_b16 v[34:35], v28 offset:1024
    ds_read_b64_tr_b16 v[36:37], v29 offset:0
    ds_read_b64_tr_b16 v[38:39], v29 offset:1024
    ds_read_b64_tr_b16 v[40:41], v30 offset:0
    ds_read_b64_tr_b16 v[42:43], v30 offset:1024
    ds_read_b64_tr_b16 v[44:45], v31 offset:0
    ds_read_b64_tr_b16 v[46:47], v31 offset:1024
    s_waitcnt lgkmcnt(12)
    v_mfma_f32_32x32x16_bf16 v[64:79], v[48:51], v[156:159], v[64:79]
    v_mfma_f32_32x32x16_bf16 v[80:95], v[52:55], v[156:159], v[80:95]
    v_mfma_f32_32x32x16_bf16 v[96:111], v[56:59], v[156:159], v[96:111]
    v_mfma_f32_32x32x16_bf16 v[112:127], v[60:63], v[156:159], v[112:127]
    ds_read_b64_tr_b16 v[48:49], v28 offset:4096
    ds_read_b64_tr_b16 v[50:51], v28 offset:5120
    ds_read_b64_tr_b16 v[52:53], v29 offset:4096
    ds_read_b64_tr_b16 v[54:55], v29 offset:5120
    ds_read_b64_tr_b16 v[56:57], v30 offset:4096
    ds_read_b64_tr_b16 v[58:59], v30 offset:5120
    ds_read_b64_tr_b16 v[60:61], v31 offset:4096
    ds_read_b64_tr_b16 v[62:63], v31 offset:5120
    v_mov_b32 v5, 13
    s_mov_b64 exec, 1
    ds_write_b32 v10, v5
    s_mov_b64 exec, -1
    s_waitcnt lgkmcnt(9)
    v_mfma_f32_32x32x16_bf16 v[64:79], v[32:35], v[128:131], v[64:79]
    v_mfma_f32_32x32x16_bf16 v[80:95], v[36:39], v[128:131], v[80:95]
    v_mfma_f32_32x32x16_bf16 v[96:111], v[40:43], v[128:131], v[96:111]
    v_mfma_f32_32x32x16_bf16 v[112:127], v[44:47], v[128:131], v[112:127]
    s_cmp_ge_u32 s48, 14
    s_cbranch_scc1 L_lok_27
L_lpoll_28:
    ds_read_b32 v4, v3 offset:0
    s_waitcnt lgkmcnt(0)
    v_readfirstlane_b32 s48, v4
    s_cmp_ge_u32 s48, 14
    s_cbranch_scc1 L_lok_27
    s_sleep 1
    s_branch L_lpoll_28
L_lok_27:
    ds_read_b64_tr_b16 v[32:33], v28 offset:8192
    ds_read_b64_tr_b16 v[34:35], v28 offset:9216
    ds_read_b64_tr_b16 v[36:37], v29 offset:8192
    ds_read_b64_tr_b16 v[38:39], v29 offset:9216
    ds_read_b64_tr_b16 v[40:41], v30 offset:8192
    ds_read_b64_tr_b16 v[42:43], v30 offset:9216
    ds_read_b64_tr_b16 v[44:45], v31 offset:8192
    ds_read_b64_tr_b16 v[46:47], v31 offset:9216
    s_waitcnt lgkmcnt(8)
    v_mfma_f32_32x32x16_bf16 v[64:79], v[48:51], v[132:135], v[64:79]
    v_mfma_f32_32x32x16_bf16 v[80:95], v[52:55], v[132:135], v[80:95]
    v_mfma_f32_32x32x16_bf16 v[96:111], v[56:59], v[132:135], v[96:111]
    v_mfma_f32_32x32x16_bf16 v[112:127], v[60:63], v[132:135], v[112:127]
    ds_read_b64_tr_b16 v[48:49], v28 offset:12288
    ds_read_b64_tr_b16 v[50:51], v28 offset:13312
    ds_read_b64_tr_b16 v[52:53], v29 offset:12288
    ds_read_b64_tr_b16 v[54:55], v29 offset:13312
    ds_read_b64_tr_b16 v[56:57], v30 offset:12288
    ds_read_b64_tr_b16 v[58:59], v30 offset:13312
    ds_read_b64_tr_b16 v[60:61], v31 offset:12288
    ds_read_b64_tr_b16 v[62:63], v31 offset:13312
    v_mov_b32 v5, 14
    s_mov_b64 exec, 1
    ds_write_b32 v10, v5
    s_mov_b64 exec, -1
    s_waitcnt lgkmcnt(9)
    v_mfma_f32_32x32x16_bf16 v[64:79], v[32:35], v[136:139], v[64:79]
    v_mfma_f32_32x32x16_bf16 v[80:95], v[36:39], v[136:139], v[80:95]
    v_mfma_f32_32x32x16_bf16 v[96:111], v[40:43], v[136:139], v[96:111]
    v_mfma_f32_32x32x16_bf16 v[112:127], v[44:47], v[136:139], v[112:127]
    s_waitcnt vmcnt(0)
    ds_read_b128 v[144:147], v160 offset:4096
    ds_read_b128 v[148:151], v161 offset:4096
    ds_read_b128 v[152:155], v162 offset:4096
    ds_read_b128 v[156:159], v163 offset:4096
    s_cmp_ge_u32 s48, 15
    s_cbranch_scc1 L_lok_29
L_lpoll_30:
    ds_read_b32 v4, v3 offset:0
    s_waitcnt lgkmcnt(0)
    v_readfirstlane_b32 s48, v4
    s_cmp_ge_u32 s48, 15
    s_cbranch_scc1 L_lok_29
    s_sleep 1
    s_branch L_lpoll_30
L_lok_29:
    ds_read_b64_tr_b16 v[32:33], v28 offset:16384
    ds_read_b64_tr_b16 v[34:35], v28 offset:17408
    ds_read_b64_tr_b16 v[36:37], v29 offset:16384
    ds_read_b64_tr_b16 v[38:39], v29 offset:17408
    ds_read_b64_tr_b16 v[40:41], v30 offset:16384
    ds_read_b64_tr_b16 v[42:43], v30 offset:17408
    ds_read_b64_tr_b16 v[44:45], v31 offset:16384
    ds_read_b64_tr_b16 v[46:47], v31 offset:17408
    s_waitcnt lgkmcnt(12)
    v_mfma_f32_32x32x16_bf16 v[64:79], v[48:51], v[140:143], v[64:79]
    v_mfma_f32_32x32x16_bf16 v[80:95], v[52:55], v[140:143], v[80:95]
    v_mfma_f32_32x32x16_bf16 v[96:111], v[56:59], v[140:143], v[96:111]
    v_mfma_f32_32x32x16_bf16 v[112:127], v[60:63], v[140:143], v[112:127]
    ds_read_b64_tr_b16 v[48:49], v28 offset:20480
    ds_read_b64_tr_b16 v[50:51], v28 offset:21504
    ds_read_b64_tr_b16 v[52:53], v29 offset:20480
    ds_read_b64_tr_b16 v[54:55], v29 offset:21504
    ds_read_b64_tr_b16 v[56:57], v30 offset:20480
    ds_read_b64_tr_b16 v[58:59], v30 offset:21504
    ds_read_b64_tr_b16 v[60:61], v31 offset:20480
    ds_read_b64_tr_b16 v[62:63], v31 offset:21504
    v_mov_b32 v5, 15
    s_mov_b64 exec, 1
    ds_write_b32 v10, v5
    s_mov_b64 exec, -1
    s_waitcnt lgkmcnt(9)
    v_mfma_f32_32x32x16_bf16 v[64:79], v[32:35], v[144:147], v[64:79]
    v_mfma_f32_32x32x16_bf16 v[80:95], v[36:39], v[144:147], v[80:95]
    v_mfma_f32_32x32x16_bf16 v[96:111], v[40:43], v[144:147], v[96:111]
    v_mfma_f32_32x32x16_bf16 v[112:127], v[44:47], v[144:147], v[112:127]
    s_cmp_ge_u32 s48, 16
    s_cbranch_scc1 L_lok_31
L_lpoll_32:
    ds_read_b32 v4, v3 offset:0
    s_waitcnt lgkmcnt(0)
    v_readfirstlane_b32 s48, v4
    s_cmp_ge_u32 s48, 16
    s_cbranch_scc1 L_lok_31
    s_sleep 1
    s_branch L_lpoll_32
L_lok_31:
    ds_read_b64_tr_b16 v[32:33], v28 offset:24576
    ds_read_b64_tr_b16 v[34:35], v28 offset:25600
    ds_read_b64_tr_b16 v[36:37], v29 offset:24576
    ds_read_b64_tr_b16 v[38:39], v29 offset:25600
    ds_read_b64_tr_b16 v[40:41], v30 offset:24576
    ds_read_b64_tr_b16 v[42:43], v30 offset:25600
    ds_read_b64_tr_b16 v[44:45], v31 offset:24576
    ds_read_b64_tr_b16 v[46:47], v31 offset:25600
    s_waitcnt lgkmcnt(8)
    v_mfma_f32_32x32x16_bf16 v[64:79], v[48:51], v[148:151], v[64:79]
    v_mfma_f32_32x32x16_bf16 v[80:95], v[52:55], v[148:151], v[80:95]
    v_mfma_f32_32x32x16_bf16 v[96:111], v[56:59], v[148:151], v[96:111]
    v_mfma_f32_32x32x16_bf16 v[112:127], v[60:63], v[148:151], v[112:127]
    ds_read_b64_tr_b16 v[48:49], v28 offset:28672
    ds_read_b64_tr_b16 v[50:51], v28 offset:29696
    ds_read_b64_tr_b16 v[52:53], v29 offset:28672
    ds_read_b64_tr_b16 v[54:55], v29 offset:29696
    ds_read_b64_tr_b16 v[56:57], v30 offset:28672
    ds_read_b64_tr_b16 v[58:59], v30 offset:29696
    ds_read_b64_tr_b16 v[60:61], v31 offset:28672
    ds_read_b64_tr_b16 v[62:63], v31 offset:29696
    v_mov_b32 v5, 16
    s_mov_b64 exec, 1
    ds_write_b32 v10, v5
    s_mov_b64 exec, -1
    s_waitcnt lgkmcnt(9)
    v_mfma_f32_32x32x16_bf16 v[64:79], v[32:35], v[152:155], v[64:79]
    v_mfma_f32_32x32x16_bf16 v[80:95], v[36:39], v[152:155], v[80:95]
    v_mfma_f32_32x32x16_bf16 v[96:111], v[40:43], v[152:155], v[96:111]
    v_mfma_f32_32x32x16_bf16 v[112:127], v[44:47], v[152:155], v[112:127]
    s_waitcnt lgkmcnt(0)
    v_mfma_f32_32x32x16_bf16 v[64:79], v[48:51], v[156:159], v[64:79]
    v_mfma_f32_32x32x16_bf16 v[80:95], v[52:55], v[156:159], v[80:95]
    v_mfma_f32_32x32x16_bf16 v[96:111], v[56:59], v[156:159], v[96:111]
    v_mfma_f32_32x32x16_bf16 v[112:127], v[60:63], v[156:159], v[112:127]
    s_nop 15
    v_mul_f32 v64, s54, v64
    v_mul_f32 v65, s54, v65
    v_mul_f32 v66, s54, v66
    v_mul_f32 v67, s54, v67
    v_mul_f32 v68, s54, v68
    v_mul_f32 v69, s54, v69
    v_mul_f32 v70, s54, v70
    v_mul_f32 v71, s54, v71
    v_mul_f32 v72, s54, v72
    v_mul_f32 v73, s54, v73
    v_mul_f32 v74, s54, v74
    v_mul_f32 v75, s54, v75
    v_mul_f32 v76, s54, v76
    v_mul_f32 v77, s54, v77
    v_mul_f32 v78, s54, v78
    v_mul_f32 v79, s54, v79
    v_mul_f32 v80, s54, v80
    v_mul_f32 v81, s54, v81
    v_mul_f32 v82, s54, v82
    v_mul_f32 v83, s54, v83
    v_mul_f32 v84, s54, v84
    v_mul_f32 v85, s54, v85
    v_mul_f32 v86, s54, v86
    v_mul_f32 v87, s54, v87
    v_mul_f32 v88, s54, v88
    v_mul_f32 v89, s54, v89
    v_mul_f32 v90, s54, v90
    v_mul_f32 v91, s54, v91
    v_mul_f32 v92, s54, v92
    v_mul_f32 v93, s54, v93
    v_mul_f32 v94, s54, v94
    v_mul_f32 v95, s54, v95
    v_mul_f32 v96, s54, v96
    v_mul_f32 v97, s54, v97
    v_mul_f32 v98, s54, v98
    v_mul_f32 v99, s54, v99
    v_mul_f32 v100, s54, v100
    v_mul_f32 v101, s54, v101
    v_mul_f32 v102, s54, v102
    v_mul_f32 v103, s54, v103
    v_mul_f32 v104, s54, v104
    v_mul_f32 v105, s54, v105
    v_mul_f32 v106, s54, v106
    v_mul_f32 v107, s54, v107
    v_mul_f32 v108, s54, v108
    v_mul_f32 v109, s54, v109
    v_mul_f32 v110, s54, v110
    v_mul_f32 v111, s54, v111
    v_mul_f32 v112, s54, v112
    v_mul_f32 v113, s54, v113
    v_mul_f32 v114, s54, v114
    v_mul_f32 v115, s54, v115
    v_mul_f32 v116, s54, v116
    v_mul_f32 v117, s54, v117
    v_mul_f32 v118, s54, v118
    v_mul_f32 v119, s54, v119
    v_mul_f32 v120, s54, v120
    v_mul_f32 v121, s54, v121
    v_mul_f32 v122, s54, v122
    v_mul_f32 v123, s54, v123
    v_mul_f32 v124, s54, v124
    v_mul_f32 v125, s54, v125
    v_mul_f32 v126, s54, v126
    v_mul_f32 v127, s54, v127
    v_cvt_pk_bf16_f32 v32, v64, v65
    v_cvt_pk_bf16_f32 v33, v66, v67
    v_cvt_pk_bf16_f32 v34, v68, v69
    v_cvt_pk_bf16_f32 v35, v70, v71
    v_cvt_pk_bf16_f32 v36, v72, v73
    v_cvt_pk_bf16_f32 v37, v74, v75
    v_cvt_pk_bf16_f32 v38, v76, v77
    v_cvt_pk_bf16_f32 v39, v78, v79
    v_cvt_pk_bf16_f32 v40, v80, v81
    v_cvt_pk_bf16_f32 v41, v82, v83
    v_cvt_pk_bf16_f32 v42, v84, v85
    v_cvt_pk_bf16_f32 v43, v86, v87
    v_cvt_pk_bf16_f32 v44, v88, v89
    v_cvt_pk_bf16_f32 v45, v90, v91
    v_cvt_pk_bf16_f32 v46, v92, v93
    v_cvt_pk_bf16_f32 v47, v94, v95
    v_cvt_pk_bf16_f32 v48, v96, v97
    v_cvt_pk_bf16_f32 v49, v98, v99
    v_cvt_pk_bf16_f32 v50, v100, v101
    v_cvt_pk_bf16_f32 v51, v102, v103
    v_cvt_pk_bf16_f32 v52, v104, v105
    v_cvt_pk_bf16_f32 v53, v106, v107
    v_cvt_pk_bf16_f32 v54, v108, v109
    v_cvt_pk_bf16_f32 v55, v110, v111
    v_cvt_pk_bf16_f32 v56, v112, v113
    v_cvt_pk_bf16_f32 v57, v114, v115
    v_cvt_pk_bf16_f32 v58, v116, v117
    v_cvt_pk_bf16_f32 v59, v118, v119
    v_cvt_pk_bf16_f32 v60, v120, v121
    v_cvt_pk_bf16_f32 v61, v122, v123
    v_cvt_pk_bf16_f32 v62, v124, v125
    v_cvt_pk_bf16_f32 v63, v126, v127
    v_lshlrev_b32 v15, 4, v2
    v_mov_b32 v64, 0
    v_mov_b32 v65, 0
    v_mov_b32 v66, 0
    v_mov_b32 v67, 0
    v_mov_b32 v68, 0
    v_mov_b32 v69, 0
    v_mov_b32 v70, 0
    v_mov_b32 v71, 0
    v_mov_b32 v72, 0
    v_mov_b32 v73, 0
    v_mov_b32 v74, 0
    v_mov_b32 v75, 0
    v_mov_b32 v76, 0
    v_mov_b32 v77, 0
    v_mov_b32 v78, 0
    v_mov_b32 v79, 0
    v_mov_b32 v80, 0
    v_mov_b32 v81, 0
    v_mov_b32 v82, 0
    v_mov_b32 v83, 0
    v_mov_b32 v84, 0
    v_mov_b32 v85, 0
    v_mov_b32 v86, 0
    v_mov_b32 v87, 0
    v_mov_b32 v88, 0
    v_mov_b32 v89, 0
    v_mov_b32 v90, 0
    v_mov_b32 v91, 0
    v_mov_b32 v92, 0
    v_mov_b32 v93, 0
    v_mov_b32 v94, 0
    v_mov_b32 v95, 0
    v_mov_b32 v96, 0
    v_mov_b32 v97, 0
    v_mov_b32 v98, 0
    v_mov_b32 v99, 0
    v_mov_b32 v100, 0
    v_mov_b32 v101, 0
    v_mov_b32 v102, 0
    v_mov_b32 v103, 0
    v_mov_b32 v104, 0
    v_mov_b32 v105, 0
    v_mov_b32 v106, 0
    v_mov_b32 v107, 0
    v_mov_b32 v108, 0
    v_mov_b32 v109, 0
    v_mov_b32 v110, 0
    v_mov_b32 v111, 0
    v_mov_b32 v112, 0
    v_mov_b32 v113, 0
    v_mov_b32 v114, 0
    v_mov_b32 v115, 0
    v_mov_b32 v116, 0
    v_mov_b32 v117, 0
    v_mov_b32 v118, 0
    v_mov_b32 v119, 0
    v_mov_b32 v120, 0
    v_mov_b32 v121, 0
    v_mov_b32 v122, 0
    v_mov_b32 v123, 0
    v_mov_b32 v124, 0
    v_mov_b32 v125, 0
    v_mov_b32 v126, 0
    v_mov_b32 v127, 0
    v_mov_b32 v12, 0
    v_mov_b32 v13, 0
    s_mov_b32 s47, 0
    s_mov_b32 s48, 0
    s_mov_b32 s50, 17
    s_cmp_ge_u32 s48, 1
    s_cbranch_scc1 L_lok_33
L_lpoll_34:
    ds_read_b32 v4, v3 offset:4
    s_waitcnt lgkmcnt(0)
    v_readfirstlane_b32 s48, v4
    s_cmp_ge_u32 s48, 1
    s_cbranch_scc1 L_lok_33
    s_sleep 1
    s_branch L_lpoll_34
L_lok_33:
    ds_read_b128 v[176:179], v16 offset:0
    ds_read_b128 v[180:183], v17 offset:0
    ds_read_b128 v[184:187], v18 offset:0
    ds_read_b128 v[188:191], v19 offset:0
    ds_read_b128 v[192:195], v20 offset:0
    ds_read_b128 v[196:199], v21 offset:0
    ds_read_b128 v[200:203], v22 offset:0
    ds_read_b128 v[204:207], v23 offset:0
    s_waitcnt lgkmcnt(0)
    v_mfma_f32_32x32x16_bf16 v[128:143], v[176:179], v[32:35], 0
    v_mfma_f32_32x32x16_bf16 v[128:143], v[180:183], v[36:39], v[128:143]
    v_mfma_f32_32x32x16_bf16 v[128:143], v[184:187], v[40:43], v[128:143]
    v_mfma_f32_32x32x16_bf16 v[128:143], v[188:191], v[44:47], v[128:143]
    v_mfma_f32_32x32x16_bf16 v[128:143], v[192:195], v[48:51], v[128:143]
    v_mfma_f32_32x32x16_bf16 v[128:143], v[196:199], v[52:55], v[128:143]
    v_mfma_f32_32x32x16_bf16 v[128:143], v[200:203], v[56:59], v[128:143]
    v_mfma_f32_32x32x16_bf16 v[128:143], v[204:207], v[60:63], v[128:143]
    s_cmp_ge_u32 s48, 2
    s_cbranch_scc1 L_lok_35
L_lpoll_36:
    ds_read_b32 v4, v3 offset:4
    s_waitcnt lgkmcnt(0)
    v_readfirstlane_b32 s48, v4
    s_cmp_ge_u32 s48, 2
    s_cbranch_scc1 L_lok_35
    s_sleep 1
    s_branch L_lpoll_36
L_lok_35:
    ds_read_b128 v[176:179], v16 offset:16384
    ds_read_b128 v[180:183], v17 offset:16384
    ds_read_b128 v[184:187], v18 offset:16384
    ds_read_b128 v[188:191], v19 offset:16384
    ds_read_b128 v[192:195], v20 offset:16384
    ds_read_b128 v[196:199], v21 offset:16384
    ds_read_b128 v[200:203], v22 offset:16384
    ds_read_b128 v[204:207], v23 offset:16384
    s_nop 11
    v_max3_f32 v168, v128, v129, v130
    v_max3_f32 v169, v131, v132, v133
    v_max3_f32 v170, v134, v135, v136
    v_max3_f32 v171, v137, v138, v139
    v_max3_f32 v172, v140, v141, v142
    v_max3_f32 v168, v168, v169, v143
    v_max3_f32 v170, v170, v171, v172
    v_max_f32 v14, v168, v170
    v_mov_b32 v168, v14
    s_nop 1
    v_permlane32_swap_b32 v168, v14
    s_nop 1
    v_max_f32 v168, v168, v14
    v_sub_f32 v169, 0, v168
    v_sub_f32 v128, v128, v168
    v_sub_f32 v129, v129, v168
    v_sub_f32 v130, v130, v168
    v_sub_f32 v131, v131, v168
    v_sub_f32 v132, v132, v168
    v_sub_f32 v133, v133, v168
    v_sub_f32 v134, v134, v168
    v_sub_f32 v135, v135, v168
    v_sub_f32 v136, v136, v168
    v_sub_f32 v137, v137, v168
    v_sub_f32 v138, v138, v168
    v_sub_f32 v139, v139, v168
    v_sub_f32 v140, v140, v168
    v_sub_f32 v141, v141, v168
    v_sub_f32 v142, v142, v168
    v_sub_f32 v143, v143, v168
    v_mov_b32 v144, v169
    v_mov_b32 v145, v169
    v_mov_b32 v146, v169
    v_mov_b32 v147, v169
    v_mov_b32 v148, v169
    v_mov_b32 v149, v169
    v_mov_b32 v150, v169
    v_mov_b32 v151, v169
    v_mov_b32 v152, v169
    v_mov_b32 v153, v169
    v_mov_b32 v154, v169
    v_mov_b32 v155, v169
    v_mov_b32 v156, v169
    v_mov_b32 v157, v169
    v_mov_b32 v158, v169
    v_mov_b32 v159, v169
    s_nop 1
L1_loop:
    s_waitcnt lgkmcnt(0)
    v_mfma_f32_32x32x16_bf16 v[240:255], v[176:179], v[32:35], v[144:159]
    ds_read_b64_tr_b16 v[208:209], v24 offset:0
    ds_read_b64_tr_b16 v[210:211], v24 offset:2048
    v_exp_f32 v128, v128
    v_exp_f32 v129, v129
    v_mfma_f32_32x32x16_bf16 v[240:255], v[180:183], v[36:39], v[240:255]
    ds_read_b64_tr_b16 v[212:213], v25 offset:0
    ds_read_b64_tr_b16 v[214:215], v25 offset:2048
    v_exp_f32 v130, v130
    v_exp_f32 v131, v131
    v_cvt_pk_bf16_f32 v160, v128, v129
    v_add_f32 v12, v12, v128
    v_add_f32 v13, v13, v129
    v_mfma_f32_32x32x16_bf16 v[240:255], v[184:187], v[40:43], v[240:255]
    ds_read_b64_tr_b16 v[216:217], v26 offset:0
    ds_read_b64_tr_b16 v[218:219], v26 offset:2048
    v_exp_f32 v132, v132
    v_exp_f32 v133, v133
    v_cvt_pk_bf16_f32 v161, v130, v131
    v_add_f32 v12, v12, v130
    v_add_f32 v13, v13, v131
    v_mfma_f32_32x32x16_bf16 v[240:255], v[188:191], v[44:47], v[240:255]
    ds_read_b64_tr_b16 v[220:221], v27 offset:0
    ds_read_b64_tr_b16 v[222:223], v27 offset:2048
    v_exp_f32 v134, v134
    v_exp_f32 v135, v135
    v_cvt_pk_bf16_f32 v162, v132, v133
    v_add_f32 v12, v12, v132
    v_add_f32 v13, v13, v133
    v_mfma_f32_32x32x16_bf16 v[240:255], v[192:195], v[48:51], v[240:255]
    ds_read_b64_tr_b16 v[224:225], v24 offset:4096
    ds_read_b64_tr_b16 v[226:227], v24 offset:6144
    v_exp_f32 v136, v136
    v_exp_f32 v137, v137
    v_cvt_pk_bf16_f32 v163, v134, v135
    v_add_f32 v12, v12, v134
    v_add_f32 v13, v13, v135
    v_mfma_f32_32x32x16_bf16 v[240:255], v[196:199], v[52:55], v[240:255]
    ds_read_b64_tr_b16 v[228:229], v25 offset:4096
    ds_read_b64_tr_b16 v[230:231], v25 offset:6144
    v_exp_f32 v138, v138
    v_exp_f32 v139, v139
    v_cvt_pk_bf16_f32 v164, v136, v137
    v_add_f32 v12, v12, v136
    v_add_f32 v13, v13, v137
    v_mfma_f32_32x32x16_bf16 v[240:255], v[200:203], v[56:59], v[240:255]
    ds_read_b64_tr_b16 v[232:233], v26 offset:4096
    ds_read_b64_tr_b16 v[234:235], v26 offset:6144
    v_exp_f32 v140, v140
    v_exp_f32 v141, v141
    v_cvt_pk_bf16_f32 v165, v138, v139
    v_add_f32 v12, v12, v138
    v_add_f32 v13, v13, v139
    v_mfma_f32_32x32x16_bf16 v[240:255], v[204:207], v[60:63], v[240:255]
    ds_read_b64_tr_b16 v[236:237], v27 offset:4096
    ds_read_b64_tr_b16 v[238:239], v27 offset:6144
    v_exp_f32 v142, v142
    v_exp_f32 v143, v143
    v_cvt_pk_bf16_f32 v166, v140, v141
    v_add_f32 v12, v12, v140
    v_add_f32 v13, v13, v141
    ds_read_b32 v4, v3 offset:4
    v_mov_b32 v5, s50
    s_mov_b64 exec, 1
    ds_write_b32 v10, v5
    s_mov_b64 exec, -1
    v_cvt_pk_bf16_f32 v167, v142, v143
    v_add_f32 v12, v12, v142
    v_add_f32 v13, v13, v143
    s_add_u32 s50, s50, 1
    s_waitcnt lgkmcnt(0)
    v_mfma_f32_32x32x16_bf16 v[64:79], v[208:211], v[160:163], v[64:79]
    v_readfirstlane_b32 s48, v4
    s_add_u32 s51, s47, 3
    s_mov_b32 s49, 0
    s_cmp_ge_u32 s48, s51
    s_cbranch_scc0 L_nopref_37
    ds_read_b128 v[176:179], v16 offset:32768
    ds_read_b128 v[180:183], v17 offset:32768
    ds_read_b128 v[184:187], v18 offset:32768
    ds_read_b128 v[188:191], v19 offset:32768
    ds_read_b128 v[192:195], v20 offset:32768
    ds_read_b128 v[196:199], v21 offset:32768
    ds_read_b128 v[200:203], v22 offset:32768
    ds_read_b128 v[204:207], v23 offset:32768
    s_mov_b32 s49, 1
L_nopref_37:
    v_mfma_f32_32x32x16_bf16 v[80:95], v[212:215], v[160:163], v[80:95]
    v_mfma_f32_32x32x16_bf16 v[96:111], v[216:219], v[160:163], v[96:111]
    v_mfma_f32_32x32x16_bf16 v[112:127], v[220:223], v[160:163], v[112:127]
    v_mfma_f32_32x32x16_bf16 v[64:79], v[224:227], v[164:167], v[64:79]
    v_max3_f32 v168, v240, v241, v242
    v_max3_f32 v169, v243, v244, v245
    v_mfma_f32_32x32x16_bf16 v[80:95], v[228:231], v[164:167], v[80:95]
    v_max3_f32 v170, v246, v247, v248
    v_max3_f32 v171, v249, v250, v251
    v_mfma_f32_32x32x16_bf16 v[96:111], v[232:235], v[164:167], v[96:111]
    v_max3_f32 v172, v252, v253, v254
    v_max3_f32 v168, v168, v169, v255
    v_mfma_f32_32x32x16_bf16 v[112:127], v[236:239], v[164:167], v[112:127]
    v_max3_f32 v170, v170, v171, v172
    v_max_f32 v14, v168, v170
    s_add_u32 s47, s47, 1
    v_cmp_lt_f32 vcc, s55, v14
    s_cbranch_vccnz L_rare_39
L_back_40:
    s_cmp_eq_u32 s49, 1
    s_cbranch_scc1 L_next_41
    s_add_u32 s51, s47, 2
    s_cmp_ge_u32 s48, s51
    s_cbranch_scc1 L_lok_42
L_lpoll_43:
    ds_read_b32 v4, v3 offset:4
    s_waitcnt lgkmcnt(0)
    v_readfirstlane_b32 s48, v4
    s_cmp_ge_u32 s48, s51
    s_cbranch_scc1 L_lok_42
    s_sleep 1
    s_branch L_lpoll_43
L_lok_42:
    ds_read_b128 v[176:179], v16 offset:32768
    ds_read_b128 v[180:183], v17 offset:32768
    ds_read_b128 v[184:187], v18 offset:32768
    ds_read_b128 v[188:191], v19 offset:32768
    ds_read_b128 v[192:195], v20 offset:32768
    ds_read_b128 v[196:199], v21 offset:32768
    ds_read_b128 v[200:203], v22 offset:32768
    ds_read_b128 v[204:207], v23 offset:32768
L_next_41:
    s_waitcnt lgkmcnt(0)
    v_mfma_f32_32x32x16_bf16 v[128:143], v[176:179], v[32:35], v[144:159]
    ds_read_b64_tr_b16 v[208:209], v24 offset:16384
    ds_read_b64_tr_b16 v[210:211], v24 offset:18432
    v_exp_f32 v240, v240
    v_exp_f32 v241, v241
    v_mfma_f32_32x32x16_bf16 v[128:143], v[180:183], v[36:39], v[128:143]
    ds_read_b64_tr_b16 v[212:213], v25 offset:16384
    ds_read_b64_tr_b16 v[214:215], v25 offset:18432
    v_exp_f32 v242, v242
    v_exp_f32 v243, v243
    v_cvt_pk_bf16_f32 v160, v240, v241
    v_add_f32 v12, v12, v240
    v_add_f32 v13, v13, v241
    v_mfma_f32_32x32x16_bf16 v[128:143], v[184:187], v[40:43], v[128:143]
    ds_read_b64_tr_b16 v[216:217], v26 offset:16384
    ds_read_b64_tr_b16 v[218:219], v26 offset:18432
    v_exp_f32 v244, v244
    v_exp_f32 v245, v245
    v_cvt_pk_bf16_f32 v161, v242, v243
    v_add_f32 v12, v12, v242
    v_add_f32 v13, v13, v243
    v_mfma_f32_32x32x16_bf16 v[128:143], v[188:191], v[44:47], v[128:143]
    ds_read_b64_tr_b16 v[220:221], v27 offset:16384
    ds_read_b64_tr_b16 v[222:223], v27 offset:18432
    v_exp_f32 v246, v246
    v_exp_f32 v247, v247
    v_cvt_pk_bf16_f32 v162, v244, v245
    v_add_f32 v12, v12, v244
    v_add_f32 v13, v13, v245
    v_mfma_f32_32x32x16_bf16 v[128:143], v[192:195], v[48:51], v[128:143]
    ds_read_b64_tr_b16 v[224:225], v24 offset:20480
    ds_read_b64_tr_b16 v[226:227], v24 offset:22528
    v_exp_f32 v248, v248
    v_exp_f32 v249, v249
    v_cvt_pk_bf16_f32 v163, v246, v247
    v_add_f32 v12, v12, v246
    v_add_f32 v13, v13, v247
    v_mfma_f32_32x32x16_bf16 v[128:143], v[196:199], v[52:55], v[128:143]
    ds_read_b64_tr_b16 v[228:229], v25 offset:20480
    ds_read_b64_tr_b16 v[230:231], v25 offset:22528
    v_exp_f32 v250, v250
    v_exp_f32 v251, v251
    v_cvt_pk_bf16_f32 v164, v248, v249
    v_add_f32 v12, v12, v248
    v_add_f32 v13, v13, v249
    v_mfma_f32_32x32x16_bf16 v[128:143], v[200:203], v[56:59], v[128:143]
    ds_read_b64_tr_b16 v[232:233], v26 offset:20480
    ds_read_b64_tr_b16 v[234:235], v26 offset:22528
    v_exp_f32 v252, v252
    v_exp_f32 v253, v253
    v_cvt_pk_bf16_f32 v165, v250, v251
    v_add_f32 v12, v12, v250
    v_add_f32 v13, v13, v251
    v_mfma_f32_32x32x16_bf16 v[128:143], v[204:207], v[60:63], v[128:143]
    ds_read_b64_tr_b16 v[236:237], v27 offset:20480
    ds_read_b64_tr_b16 v[238:239], v27 offset:22528
    v_exp_f32 v254, v254
    v_exp_f32 v255, v255
    v_cvt_pk_bf16_f32 v166, v252, v253
    v_add_f32 v12, v12, v252
    v_add_f32 v13, v13, v253
    ds_read_b32 v4, v3 offset:4
    v_mov_b32 v5, s50
    s_mov_b64 exec, 1
    ds_write_b32 v10, v5
    s_mov_b64 exec, -1
    v_cvt_pk_bf16_f32 v167, v254, v255
    v_add_f32 v12, v12, v254
    v_add_f32 v13, v13, v255
    s_add_u32 s50, s50, 1
    s_waitcnt lgkmcnt(0)
    v_mfma_f32_32x32x16_bf16 v[64:79], v[208:211], v[160:163], v[64:79]
    v_readfirstlane_b32 s48, v4
    s_add_u32 s51, s47, 3
    s_mov_b32 s49, 0
    s_cmp_ge_u32 s48, s51
    s_cbranch_scc0 L_nopref_44
    ds_read_b128 v[176:179], v16 offset:49152
    ds_read_b128 v[180:183], v17 offset:49152
    ds_read_b128 v[184:187], v18 offset:49152
    ds_read_b128 v[188:191], v19 offset:49152
    ds_read_b128 v[192:195], v20 offset:49152
    ds_read_b128 v[196:199], v21 offset:49152
    ds_read_b128 v[200:203], v22 offset:49152
    ds_read_b128 v[204:207], v23 offset:49152
    s_mov_b32 s49, 1
L_nopref_44:
    v_mfma_f32_32x32x16_bf16 v[80:95], v[212:215], v[160:163], v[80:95]
    v_mfma_f32_32x32x16_bf16 v[96:111], v[216:219], v[160:163], v[96:111]
    v_mfma_f32_32x32x16_bf16 v[112:127], v[220:223], v[160:163], v[112:127]
    v_mfma_f32_32x32x16_bf16 v[64:79], v[224:227], v[164:167], v[64:79]
    v_max3_f32 v168, v128, v129, v130
    v_max3_f32 v169, v131, v132, v133
    v_mfma_f32_32x32x16_bf16 v[80:95], v[228:231], v[164:167], v[80:95]
    v_max3_f32 v170, v134, v135, v136
    v_max3_f32 v171, v137, v138, v139
    v_mfma_f32_32x32x16_bf16 v[96:111], v[232:235], v[164:167], v[96:111]
    v_max3_f32 v172, v140, v141, v142
    v_max3_f32 v168, v168, v169, v143
    v_mfma_f32_32x32x16_bf16 v[112:127], v[236:239], v[164:167], v[112:127]
    v_max3_f32 v170, v170, v171, v172
    v_max_f32 v14, v168, v170
    s_add_u32 s47, s47, 1
    v_cmp_lt_f32 vcc, s55, v14
    s_cbranch_vccnz L_rare_46
L_back_47:
    s_cmp_eq_u32 s49, 1
    s_cbranch_scc1 L_next_48
    s_add_u32 s51, s47, 2
    s_cmp_ge_u32 s48, s51
    s_cbranch_scc1 L_lok_49
L_lpoll_50:
    ds_read_b32 v4, v3 offset:4
    s_waitcnt lgkmcnt(0)
    v_readfirstlane_b32 s48, v4
    s_cmp_ge_u32 s48, s51
    s_cbranch_scc1 L_lok_49
    s_sleep 1
    s_branch L_lpoll_50
L_lok_49:
    ds_read_b128 v[176:179], v16 offset:49152
    ds_read_b128 v[180:183], v17 offset:49152
    ds_read_b128 v[184:187], v18 offset:49152
    ds_read_b128 v[188:191], v19 offset:49152
    ds_read_b128 v[192:195], v20 offset:49152
    ds_read_b128 v[196:199], v21 offset:49152
    ds_read_b128 v[200:203], v22 offset:49152
    ds_read_b128 v[204:207], v23 offset:49152
L_next_48:
    s_waitcnt lgkmcnt(0)
    v_mfma_f32_32x32x16_bf16 v[240:255], v[176:179], v[32:35], v[144:159]
    ds_read_b64_tr_b16 v[208:209], v24 offset:32768
    ds_read_b64_tr_b16 v[210:211], v24 offset:34816
    v_exp_f32 v128, v128
    v_exp_f32 v129, v129
    v_mfma_f32_32x32x16_bf16 v[240:255], v[180:183], v[36:39], v[240:255]
    ds_read_b64_tr_b16 v[212:213], v25 offset:32768
    ds_read_b64_tr_b16 v[214:215], v25 offset:34816
    v_exp_f32 v130, v130
    v_exp_f32 v131, v131
    v_cvt_pk_bf16_f32 v160, v128, v129
    v_add_f32 v12, v12, v128
    v_add_f32 v13, v13, v129
    v_mfma_f32_32x32x16_bf16 v[240:255], v[184:187], v[40:43], v[240:255]
    ds_read_b64_tr_b16 v[216:217], v26 offset:32768
    ds_read_b64_tr_b16 v[218:219], v26 offset:34816
    v_exp_f32 v132, v132
    v_exp_f32 v133, v133
    v_cvt_pk_bf16_f32 v161, v130, v131
    v_add_f32 v12, v12, v130
    v_add_f32 v13, v13, v131
    v_mfma_f32_32x32x16_bf16 v[240:255], v[188:191], v[44:47], v[240:255]
    ds_read_b64_tr_b16 v[220:221], v27 offset:32768
    ds_read_b64_tr_b16 v[222:223], v27 offset:34816
    v_exp_f32 v134, v134
    v_exp_f32 v135, v135
    v_cvt_pk_bf16_f32 v162, v132, v133
    v_add_f32 v12, v12, v132
    v_add_f32 v13, v13, v133
    v_mfma_f32_32x32x16_bf16 v[240:255], v[192:195], v[48:51], v[240:255]
    ds_read_b64_tr_b16 v[224:225], v24 offset:36864
    ds_read_b64_tr_b16 v[226:227], v24 offset:38912
    v_exp_f32 v136, v136
    v_exp_f32 v137, v137
    v_cvt_pk_bf16_f32 v163, v134, v135
    v_add_f32 v12, v12, v134
    v_add_f32 v13, v13, v135
    v_mfma_f32_32x32x16_bf16 v[240:255], v[196:199], v[52:55], v[240:255]
    ds_read_b64_tr_b16 v[228:229], v25 offset:36864
    ds_read_b64_tr_b16 v[230:231], v25 offset:38912
    v_exp_f32 v138, v138
    v_exp_f32 v139, v139
    v_cvt_pk_bf16_f32 v164, v136, v137
    v_add_f32 v12, v12, v136
    v_add_f32 v13, v13, v137
    v_mfma_f32_32x32x16_bf16 v[240:255], v[200:203], v[56:59], v[240:255]
    ds_read_b64_tr_b16 v[232:233], v26 offset:36864
    ds_read_b64_tr_b16 v[234:235], v26 offset:38912
    v_exp_f32 v140, v140
    v_exp_f32 v141, v141
    v_cvt_pk_bf16_f32 v165, v138, v139
    v_add_f32 v12, v12, v138
    v_add_f32 v13, v13, v139
    v_mfma_f32_32x32x16_bf16 v[240:255], v[204:207], v[60:63], v[240:255]
    ds_read_b64_tr_b16 v[236:237], v27 offset:36864
    ds_read_b64_tr_b16 v[238:239], v27 offset:38912
    v_exp_f32 v142, v142
    v_exp_f32 v143, v143
    v_cvt_pk_bf16_f32 v166, v140, v141
    v_add_f32 v12, v12, v140
    v_add_f32 v13, v13, v141
    ds_read_b32 v4, v3 offset:4
    v_mov_b32 v5, s50
    s_mov_b64 exec, 1
    ds_write_b32 v10, v5
    s_mov_b64 exec, -1
    v_cvt_pk_bf16_f32 v167, v142, v143
    v_add_f32 v12, v12, v142
    v_add_f32 v13, v13, v143
    s_add_u32 s50, s50, 1
    v_xor_b32 v16, 0x10000, v16
    v_xor_b32 v17, 0x10000, v17
    v_xor_b32 v18, 0x10000, v18
    v_xor_b32 v19, 0x10000, v19
    v_xor_b32 v20, 0x10000, v20
    v_xor_b32 v21, 0x10000, v21
    v_xor_b32 v22, 0x10000, v22
    v_xor_b32 v23, 0x10000, v23
    s_waitcnt lgkmcnt(0)
    v_mfma_f32_32x32x16_bf16 v[64:79], v[208:211], v[160:163], v[64:79]
    v_readfirstlane_b32 s48, v4
    s_add_u32 s51, s47, 3
    s_mov_b32 s49, 0
    s_cmp_ge_u32 s48, s51
    s_cbranch_scc0 L_nopref_51
    ds_read_b128 v[176:179], v16 offset:0
    ds_read_b128 v[180:183], v17 offset:0
    ds_read_b128 v[184:187], v18 offset:0
    ds_read_b128 v[188:191], v19 offset:0
    ds_read_b128 v[192:195], v20 offset:0
    ds_read_b128 v[196:199], v21 offset:0
    ds_read_b128 v[200:203], v22 offset:0
    ds_read_b128 v[204:207], v23 offset:0
    s_mov_b32 s49, 1
L_nopref_51:
    v_mfma_f32_32x32x16_bf16 v[80:95], v[212:215], v[160:163], v[80:95]
    v_mfma_f32_32x32x16_bf16 v[96:111], v[216:219], v[160:163], v[96:111]
    v_mfma_f32_32x32x16_bf16 v[112:127], v[220:223], v[160:163], v[112:127]
    v_mfma_f32_32x32x16_bf16 v[64:79], v[224:227], v[164:167], v[64:79]
    v_max3_f32 v168, v240, v241, v242
    v_max3_f32 v169, v243, v244, v245
    v_mfma_f32_32x32x16_bf16 v[80:95], v[228:231], v[164:167], v[80:95]
    v_max3_f32 v170, v246, v247, v248
    v_max3_f32 v171, v249, v250, v251
    v_mfma_f32_32x32x16_bf16 v[96:111], v[232:235], v[164:167], v[96:111]
    v_max3_f32 v172, v252, v253, v254
    v_max3_f32 v168, v168, v169, v255
    v_mfma_f32_32x32x16_bf16 v[112:127], v[236:239], v[164:167], v[112:127]
    v_max3_f32 v170, v170, v171, v172
    v_max_f32 v14, v168, v170
    s_add_u32 s47, s47, 1
    v_cmp_lt_f32 vcc, s55, v14
    s_cbranch_vccnz L_rare_53
L_back_54:
    s_cmp_eq_u32 s49, 1
    s_cbranch_scc1 L_next_55
    s_add_u32 s51, s47, 2
    s_cmp_ge_u32 s48, s51
    s_cbranch_scc1 L_lok_56
L_lpoll_57:
    ds_read_b32 v4, v3 offset:4
    s_waitcnt lgkmcnt(0)
    v_readfirstlane_b32 s48, v4
    s_cmp_ge_u32 s48, s51
    s_cbranch_scc1 L_lok_56
    s_sleep 1
    s_branch L_lpoll_57
L_lok_56:
    ds_read_b128 v[176:179], v16 offset:0
    ds_read_b128 v[180:183], v17 offset:0
    ds_read_b128 v[184:187], v18 offset:0
    ds_read_b128 v[188:191], v19 offset:0
    ds_read_b128 v[192:195], v20 offset:0
    ds_read_b128 v[196:199], v21 offset:0
    ds_read_b128 v[200:203], v22 offset:0
    ds_read_b128 v[204:207], v23 offset:0
L_next_55:
    s_waitcnt lgkmcnt(0)
    v_mfma_f32_32x32x16_bf16 v[128:143], v[176:179], v[32:35], v[144:159]
    ds_read_b64_tr_b16 v[208:209], v24 offset:49152
    ds_read_b64_tr_b16 v[210:211], v24 offset:51200
    v_exp_f32 v240, v240
    v_exp_f32 v241, v241
    v_mfma_f32_32x32x16_bf16 v[128:143], v[180:183], v[36:39], v[128:143]
    ds_read_b64_tr_b16 v[212:213], v25 offset:49152
    ds_read_b64_tr_b16 v[214:215], v25 offset:51200
    v_exp_f32 v242, v242
    v_exp_f32 v243, v243
    v_cvt_pk_bf16_f32 v160, v240, v241
    v_add_f32 v12, v12, v240
    v_add_f32 v13, v13, v241
    v_mfma_f32_32x32x16_bf16 v[128:143], v[184:187], v[40:43], v[128:143]
    ds_read_b64_tr_b16 v[216:217], v26 offset:49152
    ds_read_b64_tr_b16 v[218:219], v26 offset:51200
    v_exp_f32 v244, v244
    v_exp_f32 v245, v245
    v_cvt_pk_bf16_f32 v161, v242, v243
    v_add_f32 v12, v12, v242
    v_add_f32 v13, v13, v243
    v_mfma_f32_32x32x16_bf16 v[128:143], v[188:191], v[44:47], v[128:143]
    ds_read_b64_tr_b16 v[220:221], v27 offset:49152
    ds_read_b64_tr_b16 v[222:223], v27 offset:51200
    v_exp_f32 v246, v246
    v_exp_f32 v247, v247
    v_cvt_pk_bf16_f32 v162, v244, v245
    v_add_f32 v12, v12, v244
    v_add_f32 v13, v13, v245
    v_mfma_f32_32x32x16_bf16 v[128:143], v[192:195], v[48:51], v[128:143]
    ds_read_b64_tr_b16 v[224:225], v24 offset:53248
    ds_read_b64_tr_b16 v[226:227], v24 offset:55296
    v_exp_f32 v248, v248
    v_exp_f32 v249, v249
    v_cvt_pk_bf16_f32 v163, v246, v247
    v_add_f32 v12, v12, v246
    v_add_f32 v13, v13, v247
    v_mfma_f32_32x32x16_bf16 v[128:143], v[196:199], v[52:55], v[128:143]
    ds_read_b64_tr_b16 v[228:229], v25 offset:53248
    ds_read_b64_tr_b16 v[230:231], v25 offset:55296
    v_exp_f32 v250, v250
    v_exp_f32 v251, v251
    v_cvt_pk_bf16_f32 v164, v248, v249
    v_add_f32 v12, v12, v248
    v_add_f32 v13, v13, v249
    v_mfma_f32_32x32x16_bf16 v[128:143], v[200:203], v[56:59], v[128:143]
    ds_read_b64_tr_b16 v[232:233], v26 offset:53248
    ds_read_b64_tr_b16 v[234:235], v26 offset:55296
    v_exp_f32 v252, v252
    v_exp_f32 v253, v253
    v_cvt_pk_bf16_f32 v165, v250, v251
    v_add_f32 v12, v12, v250
    v_add_f32 v13, v13, v251
    v_mfma_f32_32x32x16_bf16 v[128:143], v[204:207], v[60:63], v[128:143]
    ds_read_b64_tr_b16 v[236:237], v27 offset:53248
    ds_read_b64_tr_b16 v[238:239], v27 offset:55296
    v_exp_f32 v254, v254
    v_exp_f32 v255, v255
    v_cvt_pk_bf16_f32 v166, v252, v253
    v_add_f32 v12, v12, v252
    v_add_f32 v13, v13, v253
    ds_read_b32 v4, v3 offset:4
    v_mov_b32 v5, s50
    s_mov_b64 exec, 1
    ds_write_b32 v10, v5
    s_mov_b64 exec, -1
    v_cvt_pk_bf16_f32 v167, v254, v255
    v_add_f32 v12, v12, v254
    v_add_f32 v13, v13, v255
    s_add_u32 s50, s50, 1
    v_xor_b32 v24, 0x10000, v24
    v_xor_b32 v25, 0x10000, v25
    v_xor_b32 v26, 0x10000, v26
    v_xor_b32 v27, 0x10000, v27
    s_waitcnt lgkmcnt(0)
    v_mfma_f32_32x32x16_bf16 v[64:79], v[208:211], v[160:163], v[64:79]
    v_readfirstlane_b32 s48, v4
    s_add_u32 s51, s47, 3
    s_mov_b32 s49, 0
    s_cmp_ge_u32 s48, s51
    s_cbranch_scc0 L_nopref_58
    ds_read_b128 v[176:179], v16 offset:16384
    ds_read_b128 v[180:183], v17 offset:16384
    ds_read_b128 v[184:187], v18 offset:16384
    ds_read_b128 v[188:191], v19 offset:16384
    ds_read_b128 v[192:195], v20 offset:16384
    ds_read_b128 v[196:199], v21 offset:16384
    ds_read_b128 v[200:203], v22 offset:16384
    ds_read_b128 v[204:207], v23 offset:16384
    s_mov_b32 s49, 1
L_nopref_58:
    v_mfma_f32_32x32x16_bf16 v[80:95], v[212:215], v[160:163], v[80:95]
    v_mfma_f32_32x32x16_bf16 v[96:111], v[216:219], v[160:163], v[96:111]
    v_mfma_f32_32x32x16_bf16 v[112:127], v[220:223], v[160:163], v[112:127]
    v_mfma_f32_32x32x16_bf16 v[64:79], v[224:227], v[164:167], v[64:79]
    v_max3_f32 v168, v128, v129, v130
    v_max3_f32 v169, v131, v132, v133
    v_mfma_f32_32x32x16_bf16 v[80:95], v[228:231], v[164:167], v[80:95]
    v_max3_f32 v170, v134, v135, v136
    v_max3_f32 v171, v137, v138, v139
    v_mfma_f32_32x32x16_bf16 v[96:111], v[232:235], v[164:167], v[96:111]
    v_max3_f32 v172, v140, v141, v142
    v_max3_f32 v168, v168, v169, v143
    v_mfma_f32_32x32x16_bf16 v[112:127], v[236:239], v[164:167], v[112:127]
    v_max3_f32 v170, v170, v171, v172
    v_max_f32 v14, v168, v170
    s_add_u32 s47, s47, 1
    v_cmp_lt_f32 vcc, s55, v14
    s_cbranch_vccnz L_rare_60
L_back_61:
    s_cmp_eq_u32 s49, 1
    s_cbranch_scc1 L_next_62
    s_add_u32 s51, s47, 2
    s_cmp_ge_u32 s48, s51
    s_cbranch_scc1 L_lok_63
L_lpoll_64:
    ds_read_b32 v4, v3 offset:4
    s_waitcnt lgkmcnt(0)
    v_readfirstlane_b32 s48, v4
    s_cmp_ge_u32 s48, s51
    s_cbranch_scc1 L_lok_63
    s_sleep 1
    s_branch L_lpoll_64
L_lok_63:
    ds_read_b128 v[176:179], v16 offset:16384
    ds_read_b128 v[180:183], v17 offset:16384
    ds_read_b128 v[184:187], v18 offset:16384
    ds_read_b128 v[188:191], v19 offset:16384
    ds_read_b128 v[192:195], v20 offset:16384
    ds_read_b128 v[196:199], v21 offset:16384
    ds_read_b128 v[200:203], v22 offset:16384
    ds_read_b128 v[204:207], v23 offset:16384
L_next_62:
    s_cmp_lt_u32 s47, 28
    s_cbranch_scc1 L1_loop
    s_waitcnt lgkmcnt(0)
    v_mfma_f32_32x32x16_bf16 v[240:255], v[176:179], v[32:35], v[144:159]
    ds_read_b64_tr_b16 v[208:209], v24 offset:0
    ds_read_b64_tr_b16 v[210:211], v24 offset:2048
    v_exp_f32 v128, v128
    v_exp_f32 v129, v129
    v_mfma_f32_32x32x16_bf16 v[240:255], v[180:183], v[36:39], v[240:255]
    ds_read_b64_tr_b16 v[212:213], v25 offset:0
    ds_read_b64_tr_b16 v[214:215], v25 offset:2048
    v_exp_f32 v130, v130
    v_exp_f32 v131, v131
    v_cvt_pk_bf16_f32 v160, v128, v129
    v_add_f32 v12, v12, v128
    v_add_f32 v13, v13, v129
    v_mfma_f32_32x32x16_bf16 v[240:255], v[184:187], v[40:43], v[240:255]
    ds_read_b64_tr_b16 v[216:217], v26 offset:0
    ds_read_b64_tr_b16 v[218:219], v26 offset:2048
    v_exp_f32 v132, v132
    v_exp_f32 v133, v133
    v_cvt_pk_bf16_f32 v161, v130, v131
    v_add_f32 v12, v12, v130
    v_add_f32 v13, v13, v131
    v_mfma_f32_32x32x16_bf16 v[240:255], v[188:191], v[44:47], v[240:255]
    ds_read_b64_tr_b16 v[220:221], v27 offset:0
    ds_read_b64_tr_b16 v[222:223], v27 offset:2048
    v_exp_f32 v134, v134
    v_exp_f32 v135, v135
    v_cvt_pk_bf16_f32 v162, v132, v133
    v_add_f32 v12, v12, v132
    v_add_f32 v13, v13, v133
    v_mfma_f32_32x32x16_bf16 v[240:255], v[192:195], v[48:51], v[240:255]
    ds_read_b64_tr_b16 v[224:225], v24 offset:4096
    ds_read_b64_tr_b16 v[226:227], v24 offset:6144
    v_exp_f32 v136, v136
    v_exp_f32 v137, v137
    v_cvt_pk_bf16_f32 v163, v134, v135
    v_add_f32 v12, v12, v134
    v_add_f32 v13, v13, v135
    v_mfma_f32_32x32x16_bf16 v[240:255], v[196:199], v[52:55], v[240:255]
    ds_read_b64_tr_b16 v[228:229], v25 offset:4096
    ds_read_b64_tr_b16 v[230:231], v25 offset:6144
    v_exp_f32 v138, v138
    v_exp_f32 v139, v139
    v_cvt_pk_bf16_f32 v164, v136, v137
    v_add_f32 v12, v12, v136
    v_add_f32 v13, v13, v137
    v_mfma_f32_32x32x16_bf16 v[240:255], v[200:203], v[56:59], v[240:255]
    ds_read_b64_tr_b16 v[232:233], v26 offset:4096
    ds_read_b64_tr_b16 v[234:235], v26 offset:6144
    v_exp_f32 v140, v140
    v_exp_f32 v141, v141
    v_cvt_pk_bf16_f32 v165, v138, v139
    v_add_f32 v12, v12, v138
    v_add_f32 v13, v13, v139
    v_mfma_f32_32x32x16_bf16 v[240:255], v[204:207], v[60:63], v[240:255]
    ds_read_b64_tr_b16 v[236:237], v27 offset:4096
    ds_read_b64_tr_b16 v[238:239], v27 offset:6144
    v_exp_f32 v142, v142
    v_exp_f32 v143, v143
    v_cvt_pk_bf16_f32 v166, v140, v141
    v_add_f32 v12, v12, v140
    v_add_f32 v13, v13, v141
    ds_read_b32 v4, v3 offset:4
    v_mov_b32 v5, s50
    s_mov_b64 exec, 1
    ds_write_b32 v10, v5
    s_mov_b64 exec, -1
    v_cvt_pk_bf16_f32 v167, v142, v143
    v_add_f32 v12, v12, v142
    v_add_f32 v13, v13, v143
    s_add_u32 s50, s50, 1
    s_waitcnt lgkmcnt(0)
    v_mfma_f32_32x32x16_bf16 v[64:79], v[208:211], v[160:163], v[64:79]
    v_readfirstlane_b32 s48, v4
    s_add_u32 s51, s47, 3
    s_mov_b32 s49, 0
    s_cmp_ge_u32 s48, s51
    s_cbranch_scc0 L_nopref_65
    ds_read_b128 v[176:179], v16 offset:32768
    ds_read_b128 v[180:183], v17 offset:32768
    ds_read_b128 v[184:187], v18 offset:32768
    ds_read_b128 v[188:191], v19 offset:32768
    ds_read_b128 v[192:195], v20 offset:32768
    ds_read_b128 v[196:199], v21 offset:32768
    ds_read_b128 v[200:203], v22 offset:32768
    ds_read_b128 v[204:207], v23 offset:32768
    s_mov_b32 s49, 1
L_nopref_65:
    v_mfma_f32_32x32x16_bf16 v[80:95], v[212:215], v[160:163], v[80:95]
    v_mfma_f32_32x32x16_bf16 v[96:111], v[216:219], v[160:163], v[96:111]
    v_mfma_f32_32x32x16_bf16 v[112:127], v[220:223], v[160:163], v[112:127]
    v_mfma_f32_32x32x16_bf16 v[64:79], v[224:227], v[164:167], v[64:79]
    v_max3_f32 v168, v240, v241, v242
    v_max3_f32 v169, v243, v244, v245
    v_mfma_f32_32x32x16_bf16 v[80:95], v[228:231], v[164:167], v[80:95]
    v_max3_f32 v170, v246, v247, v248
    v_max3_f32 v171, v249, v250, v251
    v_mfma_f32_32x32x16_bf16 v[96:111], v[232:235], v[164:167], v[96:111]
    v_max3_f32 v172, v252, v253, v254
    v_max3_f32 v168, v168, v169, v255
    v_mfma_f32_32x32x16_bf16 v[112:127], v[236:239], v[164:167], v[112:127]
    v_max3_f32 v170, v170, v171, v172
    v_max_f32 v14, v168, v170
    s_add_u32 s47, s47, 1
    v_cmp_lt_f32 vcc, s55, v14
    s_cbranch_vccnz L_rare_67
L_back_68:
    s_cmp_eq_u32 s49, 1
    s_cbranch_scc1 L_next_69
    s_add_u32 s51, s47, 2
    s_cmp_ge_u32 s48, s51
    s_cbranch_scc1 L_lok_70
L_lpoll_71:
    ds_read_b32 v4, v3 offset:4
    s_waitcnt lgkmcnt(0)
    v_readfirstlane_b32 s48, v4
    s_cmp_ge_u32 s48, s51
    s_cbranch_scc1 L_lok_70
    s_sleep 1
    s_branch L_lpoll_71
L_lok_70:
    ds_read_b128 v[176:179], v16 offset:32768
    ds_read_b128 v[180:183], v17 offset:32768
    ds_read_b128 v[184:187], v18 offset:32768
    ds_read_b128 v[188:191], v19 offset:32768
    ds_read_b128 v[192:195], v20 offset:32768
    ds_read_b128 v[196:199], v21 offset:32768
    ds_read_b128 v[200:203], v22 offset:32768
    ds_read_b128 v[204:207], v23 offset:32768
L_next_69:
    s_waitcnt lgkmcnt(0)
    v_mfma_f32_32x32x16_bf16 v[128:143], v[176:179], v[32:35], v[144:159]
    ds_read_b64_tr_b16 v[208:209], v24 offset:16384
    ds_read_b64_tr_b16 v[210:211], v24 offset:18432
    v_exp_f32 v240, v240
    v_exp_f32 v241, v241
    v_mfma_f32_32x32x16_bf16 v[128:143], v[180:183], v[36:39], v[128:143]
    ds_read_b64_tr_b16 v[212:213], v25 offset:16384
    ds_read_b64_tr_b16 v[214:215], v25 offset:18432
    v_exp_f32 v242, v242
    v_exp_f32 v243, v243
    v_cvt_pk_bf16_f32 v160, v240, v241
    v_add_f32 v12, v12, v240
    v_add_f32 v13, v13, v241
    v_mfma_f32_32x32x16_bf16 v[128:143], v[184:187], v[40:43], v[128:143]
    ds_read_b64_tr_b16 v[216:217], v26 offset:16384
    ds_read_b64_tr_b16 v[218:219], v26 offset:18432
    v_exp_f32 v244, v244
    v_exp_f32 v245, v245
    v_cvt_pk_bf16_f32 v161, v242, v243
    v_add_f32 v12, v12, v242
    v_add_f32 v13, v13, v243
    v_mfma_f32_32x32x16_bf16 v[128:143], v[188:191], v[44:47], v[128:143]
    ds_read_b64_tr_b16 v[220:221], v27 offset:16384
    ds_read_b64_tr_b16 v[222:223], v27 offset:18432
    v_exp_f32 v246, v246
    v_exp_f32 v247, v247
    v_cvt_pk_bf16_f32 v162, v244, v245
    v_add_f32 v12, v12, v244
    v_add_f32 v13, v13, v245
    v_mfma_f32_32x32x16_bf16 v[128:143], v[192:195], v[48:51], v[128:143]
    ds_read_b64_tr_b16 v[224:225], v24 offset:20480
    ds_read_b64_tr_b16 v[226:227], v24 offset:22528
    v_exp_f32 v248, v248
    v_exp_f32 v249, v249
    v_cvt_pk_bf16_f32 v163, v246, v247
    v_add_f32 v12, v12, v246
    v_add_f32 v13, v13, v247
    v_mfma_f32_32x32x16_bf16 v[128:143], v[196:199], v[52:55], v[128:143]
    ds_read_b64_tr_b16 v[228:229], v25 offset:20480
    ds_read_b64_tr_b16 v[230:231], v25 offset:22528
    v_exp_f32 v250, v250
    v_exp_f32 v251, v251
    v_cvt_pk_bf16_f32 v164, v248, v249
    v_add_f32 v12, v12, v248
    v_add_f32 v13, v13, v249
    v_mfma_f32_32x32x16_bf16 v[128:143], v[200:203], v[56:59], v[128:143]
    ds_read_b64_tr_b16 v[232:233], v26 offset:20480
    ds_read_b64_tr_b16 v[234:235], v26 offset:22528
    v_exp_f32 v252, v252
    v_exp_f32 v253, v253
    v_cvt_pk_bf16_f32 v165, v250, v251
    v_add_f32 v12, v12, v250
    v_add_f32 v13, v13, v251
    v_mfma_f32_32x32x16_bf16 v[128:143], v[204:207], v[60:63], v[128:143]
    ds_read_b64_tr_b16 v[236:237], v27 offset:20480
    ds_read_b64_tr_b16 v[238:239], v27 offset:22528
    v_exp_f32 v254, v254
    v_exp_f32 v255, v255
    v_cvt_pk_bf16_f32 v166, v252, v253
    v_add_f32 v12, v12, v252
    v_add_f32 v13, v13, v253
    ds_read_b32 v4, v3 offset:4
    v_mov_b32 v5, s50
    s_mov_b64 exec, 1
    ds_write_b32 v10, v5
    s_mov_b64 exec, -1
    v_cvt_pk_bf16_f32 v167, v254, v255
    v_add_f32 v12, v12, v254
    v_add_f32 v13, v13, v255
    s_add_u32 s50, s50, 1
    s_waitcnt lgkmcnt(0)
    v_mfma_f32_32x32x16_bf16 v[64:79], v[208:211], v[160:163], v[64:79]
    v_readfirstlane_b32 s48, v4
    s_add_u32 s51, s47, 3
    s_mov_b32 s49, 0
    s_cmp_ge_u32 s48, s51
    s_cbranch_scc0 L_nopref_72
    ds_read_b128 v[176:179], v16 offset:49152
    ds_read_b128 v[180:183], v17 offset:49152
    ds_read_b128 v[184:187], v18 offset:49152
    ds_read_b128 v[188:191], v19 offset:49152
    ds_read_b128 v[192:195], v20 offset:49152
    ds_read_b128 v[196:199], v21 offset:49152
    ds_read_b128 v[200:203], v22 offset:49152
    ds_read_b128 v[204:207], v23 offset:49152
    s_mov_b32 s49, 1
L_nopref_72:
    v_mfma_f32_32x32x16_bf16 v[80:95], v[212:215], v[160:163], v[80:95]
    v_mfma_f32_32x32x16_bf16 v[96:111], v[216:219], v[160:163], v[96:111]
    v_mfma_f32_32x32x16_bf16 v[112:127], v[220:223], v[160:163], v[112:127]
    v_mfma_f32_32x32x16_bf16 v[64:79], v[224:227], v[164:167], v[64:79]
    v_max3_f32 v168, v128, v129, v130
    v_max3_f32 v169, v131, v132, v133
    v_mfma_f32_32x32x16_bf16 v[80:95], v[228:231], v[164:167], v[80:95]
    v_max3_f32 v170, v134, v135, v136
    v_max3_f32 v171, v137, v138, v139
    v_mfma_f32_32x32x16_bf16 v[96:111], v[232:235], v[164:167], v[96:111]
    v_max3_f32 v172, v140, v141, v142
    v_max3_f32 v168, v168, v169, v143
    v_mfma_f32_32x32x16_bf16 v[112:127], v[236:239], v[164:167], v[112:127]
    v_max3_f32 v170, v170, v171, v172
    v_max_f32 v14, v168, v170
    s_add_u32 s47, s47, 1
    v_cmp_lt_f32 vcc, s55, v14
    s_cbranch_vccnz L_rare_74
L_back_75:
    s_cmp_eq_u32 s49, 1
    s_cbranch_scc1 L_next_76
    s_add_u32 s51, s47, 2
    s_cmp_ge_u32 s48, s51
    s_cbranch_scc1 L_lok_77
L_lpoll_78:
    ds_read_b32 v4, v3 offset:4
    s_waitcnt lgkmcnt(0)
    v_readfirstlane_b32 s48, v4
    s_cmp_ge_u32 s48, s51
    s_cbranch_scc1 L_lok_77
    s_sleep 1
    s_branch L_lpoll_78
L_lok_77:
    ds_read_b128 v[176:179], v16 offset:49152
    ds_read_b128 v[180:183], v17 offset:49152
    ds_read_b128 v[184:187], v18 offset:49152
    ds_read_b128 v[188:191], v19 offset:49152
    ds_read_b128 v[192:195], v20 offset:49152
    ds_read_b128 v[196:199], v21 offset:49152
    ds_read_b128 v[200:203], v22 offset:49152
    ds_read_b128 v[204:207], v23 offset:49152
L_next_76:
    s_waitcnt lgkmcnt(0)
    v_mfma_f32_32x32x16_bf16 v[240:255], v[176:179], v[32:35], v[144:159]
    ds_read_b64_tr_b16 v[208:209], v24 offset:32768
    ds_read_b64_tr_b16 v[210:211], v24 offset:34816
    v_exp_f32 v128, v128
    v_exp_f32 v129, v129
    v_mfma_f32_32x32x16_bf16 v[240:255], v[180:183], v[36:39], v[240:255]
    ds_read_b64_tr_b16 v[212:213], v25 offset:32768
    ds_read_b64_tr_b16 v[214:215], v25 offset:34816
    v_exp_f32 v130, v130
    v_exp_f32 v131, v131
    v_cvt_pk_bf16_f32 v160, v128, v129
    v_add_f32 v12, v12, v128
    v_add_f32 v13, v13, v129
    v_mfma_f32_32x32x16_bf16 v[240:255], v[184:187], v[40:43], v[240:255]
    ds_read_b64_tr_b16 v[216:217], v26 offset:32768
    ds_read_b64_tr_b16 v[218:219], v26 offset:34816
    v_exp_f32 v132, v132
    v_exp_f32 v133, v133
    v_cvt_pk_bf16_f32 v161, v130, v131
    v_add_f32 v12, v12, v130
    v_add_f32 v13, v13, v131
    v_mfma_f32_32x32x16_bf16 v[240:255], v[188:191], v[44:47], v[240:255]
    ds_read_b64_tr_b16 v[220:221], v27 offset:32768
    ds_read_b64_tr_b16 v[222:223], v27 offset:34816
    v_exp_f32 v134, v134
    v_exp_f32 v135, v135
    v_cvt_pk_bf16_f32 v162, v132, v133
    v_add_f32 v12, v12, v132
    v_add_f32 v13, v13, v133
    v_mfma_f32_32x32x16_bf16 v[240:255], v[192:195], v[48:51], v[240:255]
    ds_read_b64_tr_b16 v[224:225], v24 offset:36864
    ds_read_b64_tr_b16 v[226:227], v24 offset:38912
    v_exp_f32 v136, v136
    v_exp_f32 v137, v137
    v_cvt_pk_bf16_f32 v163, v134, v135
    v_add_f32 v12, v12, v134
    v_add_f32 v13, v13, v135
    v_mfma_f32_32x32x16_bf16 v[240:255], v[196:199], v[52:55], v[240:255]
    ds_read_b64_tr_b16 v[228:229], v25 offset:36864
    ds_read_b64_tr_b16 v[230:231], v25 offset:38912
    v_exp_f32 v138, v138
    v_exp_f32 v139, v139
    v_cvt_pk_bf16_f32 v164, v136, v137
    v_add_f32 v12, v12, v136
    v_add_f32 v13, v13, v137
    v_mfma_f32_32x32x16_bf16 v[240:255], v[200:203], v[56:59], v[240:255]
    ds_read_b64_tr_b16 v[232:233], v26 offset:36864
    ds_read_b64_tr_b16 v[234:235], v26 offset:38912
    v_exp_f32 v140, v140
    v_exp_f32 v141, v141
    v_cvt_pk_bf16_f32 v165, v138, v139
    v_add_f32 v12, v12, v138
    v_add_f32 v13, v13, v139
    v_mfma_f32_32x32x16_bf16 v[240:255], v[204:207], v[60:63], v[240:255]
    ds_read_b64_tr_b16 v[236:237], v27 offset:36864
    ds_read_b64_tr_b16 v[238:239], v27 offset:38912
    v_exp_f32 v142, v142
    v_exp_f32 v143, v143
    v_cvt_pk_bf16_f32 v166, v140, v141
    v_add_f32 v12, v12, v140
    v_add_f32 v13, v13, v141
    v_mov_b32 v5, s50
    s_mov_b64 exec, 1
    ds_write_b32 v10, v5
    s_mov_b64 exec, -1
    v_cvt_pk_bf16_f32 v167, v142, v143
    v_add_f32 v12, v12, v142
    v_add_f32 v13, v13, v143
    s_add_u32 s50, s50, 1
    s_waitcnt lgkmcnt(0)
    v_mfma_f32_32x32x16_bf16 v[64:79], v[208:211], v[160:163], v[64:79]
    v_mfma_f32_32x32x16_bf16 v[80:95], v[212:215], v[160:163], v[80:95]
    v_mfma_f32_32x32x16_bf16 v[96:111], v[216:219], v[160:163], v[96:111]
    v_mfma_f32_32x32x16_bf16 v[112:127], v[220:223], v[160:163], v[112:127]
    v_mfma_f32_32x32x16_bf16 v[64:79], v[224:227], v[164:167], v[64:79]
    v_max3_f32 v168, v240, v241, v242
    v_max3_f32 v169, v243, v244, v245
    v_mfma_f32_32x32x16_bf16 v[80:95], v[228:231], v[164:167], v[80:95]
    v_max3_f32 v170, v246, v247, v248
    v_max3_f32 v171, v249, v250, v251
    v_mfma_f32_32x32x16_bf16 v[96:111], v[232:235], v[164:167], v[96:111]
    v_max3_f32 v172, v252, v253, v254
    v_max3_f32 v168, v168, v169, v255
    v_mfma_f32_32x32x16_bf16 v[112:127], v[236:239], v[164:167], v[112:127]
    v_max3_f32 v170, v170, v171, v172
    v_max_f32 v14, v168, v170
    s_add_u32 s47, s47, 1
    v_cmp_lt_f32 vcc, s55, v14
    s_cbranch_vccnz L_rare_81
L_back_82:
    ds_read_b64_tr_b16 v[208:209], v24 offset:49152
    ds_read_b64_tr_b16 v[210:211], v24 offset:51200
    v_exp_f32 v240, v240
    v_exp_f32 v241, v241
    ds_read_b64_tr_b16 v[212:213], v25 offset:49152
    ds_read_b64_tr_b16 v[214:215], v25 offset:51200
    v_exp_f32 v242, v242
    v_exp_f32 v243, v243
    v_cvt_pk_bf16_f32 v160, v240, v241
    v_add_f32 v12, v12, v240
    v_add_f32 v13, v13, v241
    ds_read_b64_tr_b16 v[216:217], v26 offset:49152
    ds_read_b64_tr_b16 v[218:219], v26 offset:51200
    v_exp_f32 v244, v244
    v_exp_f32 v245, v245
    v_cvt_pk_bf16_f32 v161, v242, v243
    v_add_f32 v12, v12, v242
    v_add_f32 v13, v13, v243
    ds_read_b64_tr_b16 v[220:221], v27 offset:49152
    ds_read_b64_tr_b16 v[222:223], v27 offset:51200
    v_exp_f32 v246, v246
    v_exp_f32 v247, v247
    v_cvt_pk_bf16_f32 v162, v244, v245
    v_add_f32 v12, v12, v244
    v_add_f32 v13, v13, v245
    ds_read_b64_tr_b16 v[224:225], v24 offset:53248
    ds_read_b64_tr_b16 v[226:227], v24 offset:55296
    v_exp_f32 v248, v248
    v_exp_f32 v249, v249
    v_cvt_pk_bf16_f32 v163, v246, v247
    v_add_f32 v12, v12, v246
    v_add_f32 v13, v13, v247
    ds_read_b64_tr_b16 v[228:229], v25 offset:53248
    ds_read_b64_tr_b16 v[230:231], v25 offset:55296
    v_exp_f32 v250, v250
    v_exp_f32 v251, v251
    v_cvt_pk_bf16_f32 v164, v248, v249
    v_add_f32 v12, v12, v248
    v_add_f32 v13, v13, v249
    ds_read_b64_tr_b16 v[232:233], v26 offset:53248
    ds_read_b64_tr_b16 v[234:235], v26 offset:55296
    v_exp_f32 v252, v252
    v_exp_f32 v253, v253
    v_cvt_pk_bf16_f32 v165, v250, v251
    v_add_f32 v12, v12, v250
    v_add_f32 v13, v13, v251
    ds_read_b64_tr_b16 v[236:237], v27 offset:53248
    ds_read_b64_tr_b16 v[238:239], v27 offset:55296
    v_exp_f32 v254, v254
    v_exp_f32 v255, v255
    v_cvt_pk_bf16_f32 v166, v252, v253
    v_add_f32 v12, v12, v252
    v_add_f32 v13, v13, v253
    v_mov_b32 v5, s50
    s_mov_b64 exec, 1
    ds_write_b32 v10, v5
    s_mov_b64 exec, -1
    v_cvt_pk_bf16_f32 v167, v254, v255
    v_add_f32 v12, v12, v254
    v_add_f32 v13, v13, v255
    s_add_u32 s50, s50, 1
    v_xor_b32 v24, 0x10000, v24
    v_xor_b32 v25, 0x10000, v25
    v_xor_b32 v26, 0x10000, v26
    v_xor_b32 v27, 0x10000, v27
    s_waitcnt lgkmcnt(0)
    v_mfma_f32_32x32x16_bf16 v[64:79], v[208:211], v[160:163], v[64:79]
    v_mfma_f32_32x32x16_bf16 v[80:95], v[212:215], v[160:163], v[80:95]
    v_mfma_f32_32x32x16_bf16 v[96:111], v[216:219], v[160:163], v[96:111]
    v_mfma_f32_32x32x16_bf16 v[112:127], v[220:223], v[160:163], v[112:127]
    v_mfma_f32_32x32x16_bf16 v[64:79], v[224:227], v[164:167], v[64:79]
    v_mfma_f32_32x32x16_bf16 v[80:95], v[228:231], v[164:167], v[80:95]
    v_mfma_f32_32x32x16_bf16 v[96:111], v[232:235], v[164:167], v[96:111]
    v_mfma_f32_32x32x16_bf16 v[112:127], v[236:239], v[164:167], v[112:127]
    s_add_u32 s47, s47, 1
L1_epi:
    v_add_f32 v12, v12, v13
    v_mov_b32 v168, v12
    s_nop 1
    v_permlane32_swap_b32 v168, v12
    s_nop 1
    v_add_f32 v168, v168, v12
    v_rcp_f32 v168, v168
    s_nop 11
    v_mul_f32 v64, v64, v168
    v_mul_f32 v65, v65, v168
    v_mul_f32 v66, v66, v168
    v_mul_f32 v67, v67, v168
    v_mul_f32 v68, v68, v168
    v_mul_f32 v69, v69, v168
    v_mul_f32 v70, v70, v168
    v_mul_f32 v71, v71, v168
    v_mul_f32 v72, v72, v168
    v_mul_f32 v73, v73, v168
    v_mul_f32 v74, v74, v168
    v_mul_f32 v75, v75, v168
    v_mul_f32 v76, v76, v168
    v_mul_f32 v77, v77, v168
    v_mul_f32 v78, v78, v168
    v_mul_f32 v79, v79, v168
    v_mul_f32 v80, v80, v168
    v_mul_f32 v81, v81, v168
    v_mul_f32 v82, v82, v168
    v_mul_f32 v83, v83, v168
    v_mul_f32 v84, v84, v168
    v_mul_f32 v85, v85, v168
    v_mul_f32 v86, v86, v168
    v_mul_f32 v87, v87, v168
    v_mul_f32 v88, v88, v168
    v_mul_f32 v89, v89, v168
    v_mul_f32 v90, v90, v168
    v_mul_f32 v91, v91, v168
    v_mul_f32 v92, v92, v168
    v_mul_f32 v93, v93, v168
    v_mul_f32 v94, v94, v168
    v_mul_f32 v95, v95, v168
    v_mul_f32 v96, v96, v168
    v_mul_f32 v97, v97, v168
    v_mul_f32 v98, v98, v168
    v_mul_f32 v99, v99, v168
    v_mul_f32 v100, v100, v168
    v_mul_f32 v101, v101, v168
    v_mul_f32 v102, v102, v168
    v_mul_f32 v103, v103, v168
    v_mul_f32 v104, v104, v168
    v_mul_f32 v105, v105, v168
    v_mul_f32 v106, v106, v168
    v_mul_f32 v107, v107, v168
    v_mul_f32 v108, v108, v168
    v_mul_f32 v109, v109, v168
    v_mul_f32 v110, v110, v168
    v_mul_f32 v111, v111, v168
    v_mul_f32 v112, v112, v168
    v_mul_f32 v113, v113, v168
    v_mul_f32 v114, v114, v168
    v_mul_f32 v115, v115, v168
    v_mul_f32 v116, v116, v168
    v_mul_f32 v117, v117, v168
    v_mul_f32 v118, v118, v168
    v_mul_f32 v119, v119, v168
    v_mul_f32 v120, v120, v168
    v_mul_f32 v121, v121, v168
    v_mul_f32 v122, v122, v168
    v_mul_f32 v123, v123, v168
    v_mul_f32 v124, v124, v168
    v_mul_f32 v125, v125, v168
    v_mul_f32 v126, v126, v168
    v_mul_f32 v127, v127, v168
    v_cvt_pk_bf16_f32 v176, v64, v65
    v_cvt_pk_bf16_f32 v177, v66, v67
    v_cvt_pk_bf16_f32 v178, v68, v69
    v_cvt_pk_bf16_f32 v179, v70, v71
    v_cvt_pk_bf16_f32 v180, v72, v73
    v_cvt_pk_bf16_f32 v181, v74, v75
    v_cvt_pk_bf16_f32 v182, v76, v77
    v_cvt_pk_bf16_f32 v183, v78, v79
    v_cvt_pk_bf16_f32 v184, v80, v81
    v_cvt_pk_bf16_f32 v185, v82, v83
    v_cvt_pk_bf16_f32 v186, v84, v85
    v_cvt_pk_bf16_f32 v187, v86, v87
    v_cvt_pk_bf16_f32 v188, v88, v89
    v_cvt_pk_bf16_f32 v189, v90, v91
    v_cvt_pk_bf16_f32 v190, v92, v93
    v_cvt_pk_bf16_f32 v191, v94, v95
    v_cvt_pk_bf16_f32 v192, v96, v97
    v_cvt_pk_bf16_f32 v193, v98, v99
    v_cvt_pk_bf16_f32 v194, v100, v101
    v_cvt_pk_bf16_f32 v195, v102, v103
    v_cvt_pk_bf16_f32 v196, v104, v105
    v_cvt_pk_bf16_f32 v197, v106, v107
    v_cvt_pk_bf16_f32 v198, v108, v109
    v_cvt_pk_bf16_f32 v199, v110, v111
    v_cvt_pk_bf16_f32 v200, v112, v113
    v_cvt_pk_bf16_f32 v201, v114, v115
    v_cvt_pk_bf16_f32 v202, v116, v117
    v_cvt_pk_bf16_f32 v203, v118, v119
    v_cvt_pk_bf16_f32 v204, v120, v121
    v_cvt_pk_bf16_f32 v205, v122, v123
    v_cvt_pk_bf16_f32 v206, v124, v125
    v_cvt_pk_bf16_f32 v207, v126, v127
    buffer_store_dwordx4 v[176:179], v15, s[32:35], 0 offen offset:0 sc1
    buffer_store_dwordx4 v[180:183], v15, s[32:35], 0 offen offset:1024 sc1
    buffer_store_dwordx4 v[184:187], v15, s[32:35], 0 offen offset:2048 sc1
    buffer_store_dwordx4 v[188:191], v15, s[32:35], 0 offen offset:3072 sc1
    s_mov_b32 s56, 4096
    buffer_store_dwordx4 v[192:195], v15, s[32:35], s56 offen offset:0 sc1
    buffer_store_dwordx4 v[196:199], v15, s[32:35], s56 offen offset:1024 sc1
    buffer_store_dwordx4 v[200:203], v15, s[32:35], s56 offen offset:2048 sc1
    buffer_store_dwordx4 v[204:207], v15, s[32:35], s56 offen offset:3072 sc1
    s_endpgm
L_rare_39:
    s_nop 15
    v_mov_b32 v168, v14
    s_nop 1
    v_permlane32_swap_b32 v168, v14
    s_nop 1
    v_max3_f32 v168, v168, v14, 0
    v_sub_f32 v169, v144, v168
    v_sub_f32 v240, v240, v168
    v_sub_f32 v241, v241, v168
    v_sub_f32 v242, v242, v168
    v_sub_f32 v243, v243, v168
    v_sub_f32 v244, v244, v168
    v_sub_f32 v245, v245, v168
    v_sub_f32 v246, v246, v168
    v_sub_f32 v247, v247, v168
    v_sub_f32 v248, v248, v168
    v_sub_f32 v249, v249, v168
    v_sub_f32 v250, v250, v168
    v_sub_f32 v251, v251, v168
    v_sub_f32 v252, v252, v168
    v_sub_f32 v253, v253, v168
    v_sub_f32 v254, v254, v168
    v_sub_f32 v255, v255, v168
    v_mov_b32 v144, v169
    v_mov_b32 v145, v169
    v_mov_b32 v146, v169
    v_mov_b32 v147, v169
    v_mov_b32 v148, v169
    v_mov_b32 v149, v169
    v_mov_b32 v150, v169
    v_mov_b32 v151, v169
    v_mov_b32 v152, v169
    v_mov_b32 v153, v169
    v_mov_b32 v154, v169
    v_mov_b32 v155, v169
    v_mov_b32 v156, v169
    v_mov_b32 v157, v169
    v_mov_b32 v158, v169
    v_mov_b32 v159, v169
    v_sub_f32 v170, 0, v168
    v_exp_f32 v170, v170
    s_nop 0
    v_mul_f32 v12, v12, v170
    v_mul_f32 v13, v13, v170
    v_mul_f32 v64, v64, v170
    v_mul_f32 v65, v65, v170
    v_mul_f32 v66, v66, v170
    v_mul_f32 v67, v67, v170
    v_mul_f32 v68, v68, v170
    v_mul_f32 v69, v69, v170
    v_mul_f32 v70, v70, v170
    v_mul_f32 v71, v71, v170
    v_mul_f32 v72, v72, v170
    v_mul_f32 v73, v73, v170
    v_mul_f32 v74, v74, v170
    v_mul_f32 v75, v75, v170
    v_mul_f32 v76, v76, v170
    v_mul_f32 v77, v77, v170
    v_mul_f32 v78, v78, v170
    v_mul_f32 v79, v79, v170
    v_mul_f32 v80, v80, v170
    v_mul_f32 v81, v81, v170
    v_mul_f32 v82, v82, v170
    v_mul_f32 v83, v83, v170
    v_mul_f32 v84, v84, v170
    v_mul_f32 v85, v85, v170
    v_mul_f32 v86, v86, v170
    v_mul_f32 v87, v87, v170
    v_mul_f32 v88, v88, v170
    v_mul_f32 v89, v89, v170
    v_mul_f32 v90, v90, v170
    v_mul_f32 v91, v91, v170
    v_mul_f32 v92, v92, v170
    v_mul_f32 v93, v93, v170
    v_mul_f32 v94, v94, v170
    v_mul_f32 v95, v95, v170
    v_mul_f32 v96, v96, v170
    v_mul_f32 v97, v97, v170
    v_mul_f32 v98, v98, v170
    v_mul_f32 v99, v99, v170
    v_mul_f32 v100, v100, v170
    v_mul_f32 v101, v101, v170
    v_mul_f32 v102, v102, v170
    v_mul_f32 v103, v103, v170
    v_mul_f32 v104, v104, v170
    v_mul_f32 v105, v105, v170
    v_mul_f32 v106, v106, v170
    v_mul_f32 v107, v107, v170
    v_mul_f32 v108, v108, v170
    v_mul_f32 v109, v109, v170
    v_mul_f32 v110, v110, v170
    v_mul_f32 v111, v111, v170
    v_mul_f32 v112, v112, v170
    v_mul_f32 v113, v113, v170
    v_mul_f32 v114, v114, v170
    v_mul_f32 v115, v115, v170
    v_mul_f32 v116, v116, v170
    v_mul_f32 v117, v117, v170
    v_mul_f32 v118, v118, v170
    v_mul_f32 v119, v119, v170
    v_mul_f32 v120, v120, v170
    v_mul_f32 v121, v121, v170
    v_mul_f32 v122, v122, v170
    v_mul_f32 v123, v123, v170
    v_mul_f32 v124, v124, v170
    v_mul_f32 v125, v125, v170
    v_mul_f32 v126, v126, v170
    v_mul_f32 v127, v127, v170
    s_branch L_back_40
L_rare_46:
    s_nop 15
    v_mov_b32 v168, v14
    s_nop 1
    v_permlane32_swap_b32 v168, v14
    s_nop 1
    v_max3_f32 v168, v168, v14, 0
    v_sub_f32 v169, v144, v168
    v_sub_f32 v128, v128, v168
    v_sub_f32 v129, v129, v168
    v_sub_f32 v130, v130, v168
    v_sub_f32 v131, v131, v168
    v_sub_f32 v132, v132, v168
    v_sub_f32 v133, v133, v168
    v_sub_f32 v134, v134, v168
    v_sub_f32 v135, v135, v168
    v_sub_f32 v136, v136, v168
    v_sub_f32 v137, v137, v168
    v_sub_f32 v138, v138, v168
    v_sub_f32 v139, v139, v168
    v_sub_f32 v140, v140, v168
    v_sub_f32 v141, v141, v168
    v_sub_f32 v142, v142, v168
    v_sub_f32 v143, v143, v168
    v_mov_b32 v144, v169
    v_mov_b32 v145, v169
    v_mov_b32 v146, v169
    v_mov_b32 v147, v169
    v_mov_b32 v148, v169
    v_mov_b32 v149, v169
    v_mov_b32 v150, v169
    v_mov_b32 v151, v169
    v_mov_b32 v152, v169
    v_mov_b32 v153, v169
    v_mov_b32 v154, v169
    v_mov_b32 v155, v169
    v_mov_b32 v156, v169
    v_mov_b32 v157, v169
    v_mov_b32 v158, v169
    v_mov_b32 v159, v169
    v_sub_f32 v170, 0, v168
    v_exp_f32 v170, v170
    s_nop 0
    v_mul_f32 v12, v12, v170
    v_mul_f32 v13, v13, v170
    v_mul_f32 v64, v64, v170
    v_mul_f32 v65, v65, v170
    v_mul_f32 v66, v66, v170
    v_mul_f32 v67, v67, v170
    v_mul_f32 v68, v68, v170
    v_mul_f32 v69, v69, v170
    v_mul_f32 v70, v70, v170
    v_mul_f32 v71, v71, v170
    v_mul_f32 v72, v72, v170
    v_mul_f32 v73, v73, v170
    v_mul_f32 v74, v74, v170
    v_mul_f32 v75, v75, v170
    v_mul_f32 v76, v76, v170
    v_mul_f32 v77, v77, v170
    v_mul_f32 v78, v78, v170
    v_mul_f32 v79, v79, v170
    v_mul_f32 v80, v80, v170
    v_mul_f32 v81, v81, v170
    v_mul_f32 v82, v82, v170
    v_mul_f32 v83, v83, v170
    v_mul_f32 v84, v84, v170
    v_mul_f32 v85, v85, v170
    v_mul_f32 v86, v86, v170
    v_mul_f32 v87, v87, v170
    v_mul_f32 v88, v88, v170
    v_mul_f32 v89, v89, v170
    v_mul_f32 v90, v90, v170
    v_mul_f32 v91, v91, v170
    v_mul_f32 v92, v92, v170
    v_mul_f32 v93, v93, v170
    v_mul_f32 v94, v94, v170
    v_mul_f32 v95, v95, v170
    v_mul_f32 v96, v96, v170
    v_mul_f32 v97, v97, v170
    v_mul_f32 v98, v98, v170
    v_mul_f32 v99, v99, v170
    v_mul_f32 v100, v100, v170
    v_mul_f32 v101, v101, v170
    v_mul_f32 v102, v102, v170
    v_mul_f32 v103, v103, v170
    v_mul_f32 v104, v104, v170
    v_mul_f32 v105, v105, v170
    v_mul_f32 v106, v106, v170
    v_mul_f32 v107, v107, v170
    v_mul_f32 v108, v108, v170
    v_mul_f32 v109, v109, v170
    v_mul_f32 v110, v110, v170
    v_mul_f32 v111, v111, v170
    v_mul_f32 v112, v112, v170
    v_mul_f32 v113, v113, v170
    v_mul_f32 v114, v114, v170
    v_mul_f32 v115, v115, v170
    v_mul_f32 v116, v116, v170
    v_mul_f32 v117, v117, v170
    v_mul_f32 v118, v118, v170
    v_mul_f32 v119, v119, v170
    v_mul_f32 v120, v120, v170
    v_mul_f32 v121, v121, v170
    v_mul_f32 v122, v122, v170
    v_mul_f32 v123, v123, v170
    v_mul_f32 v124, v124, v170
    v_mul_f32 v125, v125, v170
    v_mul_f32 v126, v126, v170
    v_mul_f32 v127, v127, v170
    s_branch L_back_47
L_rare_53:
    s_nop 15
    v_mov_b32 v168, v14
    s_nop 1
    v_permlane32_swap_b32 v168, v14
    s_nop 1
    v_max3_f32 v168, v168, v14, 0
    v_sub_f32 v169, v144, v168
    v_sub_f32 v240, v240, v168
    v_sub_f32 v241, v241, v168
    v_sub_f32 v242, v242, v168
    v_sub_f32 v243, v243, v168
    v_sub_f32 v244, v244, v168
    v_sub_f32 v245, v245, v168
    v_sub_f32 v246, v246, v168
    v_sub_f32 v247, v247, v168
    v_sub_f32 v248, v248, v168
    v_sub_f32 v249, v249, v168
    v_sub_f32 v250, v250, v168
    v_sub_f32 v251, v251, v168
    v_sub_f32 v252, v252, v168
    v_sub_f32 v253, v253, v168
    v_sub_f32 v254, v254, v168
    v_sub_f32 v255, v255, v168
    v_mov_b32 v144, v169
    v_mov_b32 v145, v169
    v_mov_b32 v146, v169
    v_mov_b32 v147, v169
    v_mov_b32 v148, v169
    v_mov_b32 v149, v169
    v_mov_b32 v150, v169
    v_mov_b32 v151, v169
    v_mov_b32 v152, v169
    v_mov_b32 v153, v169
    v_mov_b32 v154, v169
    v_mov_b32 v155, v169
    v_mov_b32 v156, v169
    v_mov_b32 v157, v169
    v_mov_b32 v158, v169
    v_mov_b32 v159, v169
    v_sub_f32 v170, 0, v168
    v_exp_f32 v170, v170
    s_nop 0
    v_mul_f32 v12, v12, v170
    v_mul_f32 v13, v13, v170
    v_mul_f32 v64, v64, v170
    v_mul_f32 v65, v65, v170
    v_mul_f32 v66, v66, v170
    v_mul_f32 v67, v67, v170
    v_mul_f32 v68, v68, v170
    v_mul_f32 v69, v69, v170
    v_mul_f32 v70, v70, v170
    v_mul_f32 v71, v71, v170
    v_mul_f32 v72, v72, v170
    v_mul_f32 v73, v73, v170
    v_mul_f32 v74, v74, v170
    v_mul_f32 v75, v75, v170
    v_mul_f32 v76, v76, v170
    v_mul_f32 v77, v77, v170
    v_mul_f32 v78, v78, v170
    v_mul_f32 v79, v79, v170
    v_mul_f32 v80, v80, v170
    v_mul_f32 v81, v81, v170
    v_mul_f32 v82, v82, v170
    v_mul_f32 v83, v83, v170
    v_mul_f32 v84, v84, v170
    v_mul_f32 v85, v85, v170
    v_mul_f32 v86, v86, v170
    v_mul_f32 v87, v87, v170
    v_mul_f32 v88, v88, v170
    v_mul_f32 v89, v89, v170
    v_mul_f32 v90, v90, v170
    v_mul_f32 v91, v91, v170
    v_mul_f32 v92, v92, v170
    v_mul_f32 v93, v93, v170
    v_mul_f32 v94, v94, v170
    v_mul_f32 v95, v95, v170
    v_mul_f32 v96, v96, v170
    v_mul_f32 v97, v97, v170
    v_mul_f32 v98, v98, v170
    v_mul_f32 v99, v99, v170
    v_mul_f32 v100, v100, v170
    v_mul_f32 v101, v101, v170
    v_mul_f32 v102, v102, v170
    v_mul_f32 v103, v103, v170
    v_mul_f32 v104, v104, v170
    v_mul_f32 v105, v105, v170
    v_mul_f32 v106, v106, v170
    v_mul_f32 v107, v107, v170
    v_mul_f32 v108, v108, v170
    v_mul_f32 v109, v109, v170
    v_mul_f32 v110, v110, v170
    v_mul_f32 v111, v111, v170
    v_mul_f32 v112, v112, v170
    v_mul_f32 v113, v113, v170
    v_mul_f32 v114, v114, v170
    v_mul_f32 v115, v115, v170
    v_mul_f32 v116, v116, v170
    v_mul_f32 v117, v117, v170
    v_mul_f32 v118, v118, v170
    v_mul_f32 v119, v119, v170
    v_mul_f32 v120, v120, v170
    v_mul_f32 v121, v121, v170
    v_mul_f32 v122, v122, v170
    v_mul_f32 v123, v123, v170
    v_mul_f32 v124, v124, v170
    v_mul_f32 v125, v125, v170
    v_mul_f32 v126, v126, v170
    v_mul_f32 v127, v127, v170
    s_branch L_back_54
L_rare_60:
    s_nop 15
    v_mov_b32 v168, v14
    s_nop 1
    v_permlane32_swap_b32 v168, v14
    s_nop 1
    v_max3_f32 v168, v168, v14, 0
    v_sub_f32 v169, v144, v168
    v_sub_f32 v128, v128, v168
    v_sub_f32 v129, v129, v168
    v_sub_f32 v130, v130, v168
    v_sub_f32 v131, v131, v168
    v_sub_f32 v132, v132, v168
    v_sub_f32 v133, v133, v168
    v_sub_f32 v134, v134, v168
    v_sub_f32 v135, v135, v168
    v_sub_f32 v136, v136, v168
    v_sub_f32 v137, v137, v168
    v_sub_f32 v138, v138, v168
    v_sub_f32 v139, v139, v168
    v_sub_f32 v140, v140, v168
    v_sub_f32 v141, v141, v168
    v_sub_f32 v142, v142, v168
    v_sub_f32 v143, v143, v168
    v_mov_b32 v144, v169
    v_mov_b32 v145, v169
    v_mov_b32 v146, v169
    v_mov_b32 v147, v169
    v_mov_b32 v148, v169
    v_mov_b32 v149, v169
    v_mov_b32 v150, v169
    v_mov_b32 v151, v169
    v_mov_b32 v152, v169
    v_mov_b32 v153, v169
    v_mov_b32 v154, v169
    v_mov_b32 v155, v169
    v_mov_b32 v156, v169
    v_mov_b32 v157, v169
    v_mov_b32 v158, v169
    v_mov_b32 v159, v169
    v_sub_f32 v170, 0, v168
    v_exp_f32 v170, v170
    s_nop 0
    v_mul_f32 v12, v12, v170
    v_mul_f32 v13, v13, v170
    v_mul_f32 v64, v64, v170
    v_mul_f32 v65, v65, v170
    v_mul_f32 v66, v66, v170
    v_mul_f32 v67, v67, v170
    v_mul_f32 v68, v68, v170
    v_mul_f32 v69, v69, v170
    v_mul_f32 v70, v70, v170
    v_mul_f32 v71, v71, v170
    v_mul_f32 v72, v72, v170
    v_mul_f32 v73, v73, v170
    v_mul_f32 v74, v74, v170
    v_mul_f32 v75, v75, v170
    v_mul_f32 v76, v76, v170
    v_mul_f32 v77, v77, v170
    v_mul_f32 v78, v78, v170
    v_mul_f32 v79, v79, v170
    v_mul_f32 v80, v80, v170
    v_mul_f32 v81, v81, v170
    v_mul_f32 v82, v82, v170
    v_mul_f32 v83, v83, v170
    v_mul_f32 v84, v84, v170
    v_mul_f32 v85, v85, v170
    v_mul_f32 v86, v86, v170
    v_mul_f32 v87, v87, v170
    v_mul_f32 v88, v88, v170
    v_mul_f32 v89, v89, v170
    v_mul_f32 v90, v90, v170
    v_mul_f32 v91, v91, v170
    v_mul_f32 v92, v92, v170
    v_mul_f32 v93, v93, v170
    v_mul_f32 v94, v94, v170
    v_mul_f32 v95, v95, v170
    v_mul_f32 v96, v96, v170
    v_mul_f32 v97, v97, v170
    v_mul_f32 v98, v98, v170
    v_mul_f32 v99, v99, v170
    v_mul_f32 v100, v100, v170
    v_mul_f32 v101, v101, v170
    v_mul_f32 v102, v102, v170
    v_mul_f32 v103, v103, v170
    v_mul_f32 v104, v104, v170
    v_mul_f32 v105, v105, v170
    v_mul_f32 v106, v106, v170
    v_mul_f32 v107, v107, v170
    v_mul_f32 v108, v108, v170
    v_mul_f32 v109, v109, v170
    v_mul_f32 v110, v110, v170
    v_mul_f32 v111, v111, v170
    v_mul_f32 v112, v112, v170
    v_mul_f32 v113, v113, v170
    v_mul_f32 v114, v114, v170
    v_mul_f32 v115, v115, v170
    v_mul_f32 v116, v116, v170
    v_mul_f32 v117, v117, v170
    v_mul_f32 v118, v118, v170
    v_mul_f32 v119, v119, v170
    v_mul_f32 v120, v120, v170
    v_mul_f32 v121, v121, v170
    v_mul_f32 v122, v122, v170
    v_mul_f32 v123, v123, v170
    v_mul_f32 v124, v124, v170
    v_mul_f32 v125, v125, v170
    v_mul_f32 v126, v126, v170
    v_mul_f32 v127, v127, v170
    s_branch L_back_61
L_rare_67:
    s_nop 15
    v_mov_b32 v168, v14
    s_nop 1
    v_permlane32_swap_b32 v168, v14
    s_nop 1
    v_max3_f32 v168, v168, v14, 0
    v_sub_f32 v169, v144, v168
    v_sub_f32 v240, v240, v168
    v_sub_f32 v241, v241, v168
    v_sub_f32 v242, v242, v168
    v_sub_f32 v243, v243, v168
    v_sub_f32 v244, v244, v168
    v_sub_f32 v245, v245, v168
    v_sub_f32 v246, v246, v168
    v_sub_f32 v247, v247, v168
    v_sub_f32 v248, v248, v168
    v_sub_f32 v249, v249, v168
    v_sub_f32 v250, v250, v168
    v_sub_f32 v251, v251, v168
    v_sub_f32 v252, v252, v168
    v_sub_f32 v253, v253, v168
    v_sub_f32 v254, v254, v168
    v_sub_f32 v255, v255, v168
    v_mov_b32 v144, v169
    v_mov_b32 v145, v169
    v_mov_b32 v146, v169
    v_mov_b32 v147, v169
    v_mov_b32 v148, v169
    v_mov_b32 v149, v169
    v_mov_b32 v150, v169
    v_mov_b32 v151, v169
    v_mov_b32 v152, v169
    v_mov_b32 v153, v169
    v_mov_b32 v154, v169
    v_mov_b32 v155, v169
    v_mov_b32 v156, v169
    v_mov_b32 v157, v169
    v_mov_b32 v158, v169
    v_mov_b32 v159, v169
    v_sub_f32 v170, 0, v168
    v_exp_f32 v170, v170
    s_nop 0
    v_mul_f32 v12, v12, v170
    v_mul_f32 v13, v13, v170
    v_mul_f32 v64, v64, v170
    v_mul_f32 v65, v65, v170
    v_mul_f32 v66, v66, v170
    v_mul_f32 v67, v67, v170
    v_mul_f32 v68, v68, v170
    v_mul_f32 v69, v69, v170
    v_mul_f32 v70, v70, v170
    v_mul_f32 v71, v71, v170
    v_mul_f32 v72, v72, v170
    v_mul_f32 v73, v73, v170
    v_mul_f32 v74, v74, v170
    v_mul_f32 v75, v75, v170
    v_mul_f32 v76, v76, v170
    v_mul_f32 v77, v77, v170
    v_mul_f32 v78, v78, v170
    v_mul_f32 v79, v79, v170
    v_mul_f32 v80, v80, v170
    v_mul_f32 v81, v81, v170
    v_mul_f32 v82, v82, v170
    v_mul_f32 v83, v83, v170
    v_mul_f32 v84, v84, v170
    v_mul_f32 v85, v85, v170
    v_mul_f32 v86, v86, v170
    v_mul_f32 v87, v87, v170
    v_mul_f32 v88, v88, v170
    v_mul_f32 v89, v89, v170
    v_mul_f32 v90, v90, v170
    v_mul_f32 v91, v91, v170
    v_mul_f32 v92, v92, v170
    v_mul_f32 v93, v93, v170
    v_mul_f32 v94, v94, v170
    v_mul_f32 v95, v95, v170
    v_mul_f32 v96, v96, v170
    v_mul_f32 v97, v97, v170
    v_mul_f32 v98, v98, v170
    v_mul_f32 v99, v99, v170
    v_mul_f32 v100, v100, v170
    v_mul_f32 v101, v101, v170
    v_mul_f32 v102, v102, v170
    v_mul_f32 v103, v103, v170
    v_mul_f32 v104, v104, v170
    v_mul_f32 v105, v105, v170
    v_mul_f32 v106, v106, v170
    v_mul_f32 v107, v107, v170
    v_mul_f32 v108, v108, v170
    v_mul_f32 v109, v109, v170
    v_mul_f32 v110, v110, v170
    v_mul_f32 v111, v111, v170
    v_mul_f32 v112, v112, v170
    v_mul_f32 v113, v113, v170
    v_mul_f32 v114, v114, v170
    v_mul_f32 v115, v115, v170
    v_mul_f32 v116, v116, v170
    v_mul_f32 v117, v117, v170
    v_mul_f32 v118, v118, v170
    v_mul_f32 v119, v119, v170
    v_mul_f32 v120, v120, v170
    v_mul_f32 v121, v121, v170
    v_mul_f32 v122, v122, v170
    v_mul_f32 v123, v123, v170
    v_mul_f32 v124, v124, v170
    v_mul_f32 v125, v125, v170
    v_mul_f32 v126, v126, v170
    v_mul_f32 v127, v127, v170
    s_branch L_back_68
L_rare_74:
    s_nop 15
    v_mov_b32 v168, v14
    s_nop 1
    v_permlane32_swap_b32 v168, v14
    s_nop 1
    v_max3_f32 v168, v168, v14, 0
    v_sub_f32 v169, v144, v168
    v_sub_f32 v128, v128, v168
    v_sub_f32 v129, v129, v168
    v_sub_f32 v130, v130, v168
    v_sub_f32 v131, v131, v168
    v_sub_f32 v132, v132, v168
    v_sub_f32 v133, v133, v168
    v_sub_f32 v134, v134, v168
    v_sub_f32 v135, v135, v168
    v_sub_f32 v136, v136, v168
    v_sub_f32 v137, v137, v168
    v_sub_f32 v138, v138, v168
    v_sub_f32 v139, v139, v168
    v_sub_f32 v140, v140, v168
    v_sub_f32 v141, v141, v168
    v_sub_f32 v142, v142, v168
    v_sub_f32 v143, v143, v168
    v_mov_b32 v144, v169
    v_mov_b32 v145, v169
    v_mov_b32 v146, v169
    v_mov_b32 v147, v169
    v_mov_b32 v148, v169
    v_mov_b32 v149, v169
    v_mov_b32 v150, v169
    v_mov_b32 v151, v169
    v_mov_b32 v152, v169
    v_mov_b32 v153, v169
    v_mov_b32 v154, v169
    v_mov_b32 v155, v169
    v_mov_b32 v156, v169
    v_mov_b32 v157, v169
    v_mov_b32 v158, v169
    v_mov_b32 v159, v169
    v_sub_f32 v170, 0, v168
    v_exp_f32 v170, v170
    s_nop 0
    v_mul_f32 v12, v12, v170
    v_mul_f32 v13, v13, v170
    v_mul_f32 v64, v64, v170
    v_mul_f32 v65, v65, v170
    v_mul_f32 v66, v66, v170
    v_mul_f32 v67, v67, v170
    v_mul_f32 v68, v68, v170
    v_mul_f32 v69, v69, v170
    v_mul_f32 v70, v70, v170
    v_mul_f32 v71, v71, v170
    v_mul_f32 v72, v72, v170
    v_mul_f32 v73, v73, v170
    v_mul_f32 v74, v74, v170
    v_mul_f32 v75, v75, v170
    v_mul_f32 v76, v76, v170
    v_mul_f32 v77, v77, v170
    v_mul_f32 v78, v78, v170
    v_mul_f32 v79, v79, v170
    v_mul_f32 v80, v80, v170
    v_mul_f32 v81, v81, v170
    v_mul_f32 v82, v82, v170
    v_mul_f32 v83, v83, v170
    v_mul_f32 v84, v84, v170
    v_mul_f32 v85, v85, v170
    v_mul_f32 v86, v86, v170
    v_mul_f32 v87, v87, v170
    v_mul_f32 v88, v88, v170
    v_mul_f32 v89, v89, v170
    v_mul_f32 v90, v90, v170
    v_mul_f32 v91, v91, v170
    v_mul_f32 v92, v92, v170
    v_mul_f32 v93, v93, v170
    v_mul_f32 v94, v94, v170
    v_mul_f32 v95, v95, v170
    v_mul_f32 v96, v96, v170
    v_mul_f32 v97, v97, v170
    v_mul_f32 v98, v98, v170
    v_mul_f32 v99, v99, v170
    v_mul_f32 v100, v100, v170
    v_mul_f32 v101, v101, v170
    v_mul_f32 v102, v102, v170
    v_mul_f32 v103, v103, v170
    v_mul_f32 v104, v104, v170
    v_mul_f32 v105, v105, v170
    v_mul_f32 v106, v106, v170
    v_mul_f32 v107, v107, v170
    v_mul_f32 v108, v108, v170
    v_mul_f32 v109, v109, v170
    v_mul_f32 v110, v110, v170
    v_mul_f32 v111, v111, v170
    v_mul_f32 v112, v112, v170
    v_mul_f32 v113, v113, v170
    v_mul_f32 v114, v114, v170
    v_mul_f32 v115, v115, v170
    v_mul_f32 v116, v116, v170
    v_mul_f32 v117, v117, v170
    v_mul_f32 v118, v118, v170
    v_mul_f32 v119, v119, v170
    v_mul_f32 v120, v120, v170
    v_mul_f32 v121, v121, v170
    v_mul_f32 v122, v122, v170
    v_mul_f32 v123, v123, v170
    v_mul_f32 v124, v124, v170
    v_mul_f32 v125, v125, v170
    v_mul_f32 v126, v126, v170
    v_mul_f32 v127, v127, v170
    s_branch L_back_75
L_rare_81:
    s_nop 15
    v_mov_b32 v168, v14
    s_nop 1
    v_permlane32_swap_b32 v168, v14
    s_nop 1
    v_max3_f32 v168, v168, v14, 0
    v_sub_f32 v169, v144, v168
    v_sub_f32 v240, v240, v168
    v_sub_f32 v241, v241, v168
    v_sub_f32 v242, v242, v168
    v_sub_f32 v243, v243, v168
    v_sub_f32 v244, v244, v168
    v_sub_f32 v245, v245, v168
    v_sub_f32 v246, v246, v168
    v_sub_f32 v247, v247, v168
    v_sub_f32 v248, v248, v168
    v_sub_f32 v249, v249, v168
    v_sub_f32 v250, v250, v168
    v_sub_f32 v251, v251, v168
    v_sub_f32 v252, v252, v168
    v_sub_f32 v253, v253, v168
    v_sub_f32 v254, v254, v168
    v_sub_f32 v255, v255, v168
    v_mov_b32 v144, v169
    v_mov_b32 v145, v169
    v_mov_b32 v146, v169
    v_mov_b32 v147, v169
    v_mov_b32 v148, v169
    v_mov_b32 v149, v169
    v_mov_b32 v150, v169
    v_mov_b32 v151, v169
    v_mov_b32 v152, v169
    v_mov_b32 v153, v169
    v_mov_b32 v154, v169
    v_mov_b32 v155, v169
    v_mov_b32 v156, v169
    v_mov_b32 v157, v169
    v_mov_b32 v158, v169
    v_mov_b32 v159, v169
    v_sub_f32 v170, 0, v168
    v_exp_f32 v170, v170
    s_nop 0
    v_mul_f32 v12, v12, v170
    v_mul_f32 v13, v13, v170
    v_mul_f32 v64, v64, v170
    v_mul_f32 v65, v65, v170
    v_mul_f32 v66, v66, v170
    v_mul_f32 v67, v67, v170
    v_mul_f32 v68, v68, v170
    v_mul_f32 v69, v69, v170
    v_mul_f32 v70, v70, v170
    v_mul_f32 v71, v71, v170
    v_mul_f32 v72, v72, v170
    v_mul_f32 v73, v73, v170
    v_mul_f32 v74, v74, v170
    v_mul_f32 v75, v75, v170
    v_mul_f32 v76, v76, v170
    v_mul_f32 v77, v77, v170
    v_mul_f32 v78, v78, v170
    v_mul_f32 v79, v79, v170
    v_mul_f32 v80, v80, v170
    v_mul_f32 v81, v81, v170
    v_mul_f32 v82, v82, v170
    v_mul_f32 v83, v83, v170
    v_mul_f32 v84, v84, v170
    v_mul_f32 v85, v85, v170
    v_mul_f32 v86, v86, v170
    v_mul_f32 v87, v87, v170
    v_mul_f32 v88, v88, v170
    v_mul_f32 v89, v89, v170
    v_mul_f32 v90, v90, v170
    v_mul_f32 v91, v91, v170
    v_mul_f32 v92, v92, v170
    v_mul_f32 v93, v93, v170
    v_mul_f32 v94, v94, v170
    v_mul_f32 v95, v95, v170
    v_mul_f32 v96, v96, v170
    v_mul_f32 v97, v97, v170
    v_mul_f32 v98, v98, v170
    v_mul_f32 v99, v99, v170
    v_mul_f32 v100, v100, v170
    v_mul_f32 v101, v101, v170
    v_mul_f32 v102, v102, v170
    v_mul_f32 v103, v103, v170
    v_mul_f32 v104, v104, v170
    v_mul_f32 v105, v105, v170
    v_mul_f32 v106, v106, v170
    v_mul_f32 v107, v107, v170
    v_mul_f32 v108, v108, v170
    v_mul_f32 v109, v109, v170
    v_mul_f32 v110, v110, v170
    v_mul_f32 v111, v111, v170
    v_mul_f32 v112, v112, v170
    v_mul_f32 v113, v113, v170
    v_mul_f32 v114, v114, v170
    v_mul_f32 v115, v115, v170
    v_mul_f32 v116, v116, v170
    v_mul_f32 v117, v117, v170
    v_mul_f32 v118, v118, v170
    v_mul_f32 v119, v119, v170
    v_mul_f32 v120, v120, v170
    v_mul_f32 v121, v121, v170
    v_mul_f32 v122, v122, v170
    v_mul_f32 v123, v123, v170
    v_mul_f32 v124, v124, v170
    v_mul_f32 v125, v125, v170
    v_mul_f32 v126, v126, v170
    v_mul_f32 v127, v127, v170
    s_branch L_back_82
L1_producer:
    s_setprio 3
    s_lshl_b32 s51, s45, 8
    s_sub_u32 s52, 4194304, s51
    s_add_u32 s24, s10, s51
    s_addc_u32 s25, s11, 0
    s_and_b32 s25, s25, 0xffff
    s_mov_b32 s26, s52
    s_mov_b32 s27, 0x00020000
    v_lshrrev_b32 v17, 4, v2
    v_and_b32 v18, 15, v2
    v_lshlrev_b32 v19, 2, v17
    v_xor_b32 v19, v19, v18
    v_lshlrev_b32 v19, 4, v19
    v_lshl_add_u32 v12, v17, 8, v19
    v_lshl_add_u32 v13, v17, 13, v19
    s_mov_b32 m0, 106496
    s_mov_b32 s56, 0
    buffer_load_dwordx4 v13, s[24:27], s56 offen lds
    s_mov_b32 m0, 107520
    s_mov_b32 s56, 32768
    buffer_load_dwordx4 v13, s[24:27], s56 offen lds
    s_mov_b32 m0, 108544
    s_mov_b32 s56, 65536
    buffer_load_dwordx4 v13, s[24:27], s56 offen lds
    s_mov_b32 m0, 109568
    s_mov_b32 s56, 98304
    buffer_load_dwordx4 v13, s[24:27], s56 offen lds
    s_mov_b32 m0, 110592
    s_mov_b32 s56, 131072
    buffer_load_dwordx4 v13, s[24:27], s56 offen lds
    s_mov_b32 m0, 111616
    s_mov_b32 s56, 163840
    buffer_load_dwordx4 v13, s[24:27], s56 offen lds
    s_mov_b32 m0, 112640
    s_mov_b32 s56, 196608
    buffer_load_dwordx4 v13, s[24:27], s56 offen lds
    s_mov_b32 m0, 113664
    s_mov_b32 s56, 229376
    buffer_load_dwordx4 v13, s[24:27], s56 offen lds
    s_mov_b32 m0, 114688
    s_mov_b32 s56, 262144
    buffer_load_dwordx4 v13, s[24:27], s56 offen lds
    s_mov_b32 m0, 115712
    s_mov_b32 s56, 294912
    buffer_load_dwordx4 v13, s[24:27], s56 offen lds
    s_mov_b32 m0, 116736
    s_mov_b32 s56, 327680
    buffer_load_dwordx4 v13, s[24:27], s56 offen lds
    s_mov_b32 m0, 117760
    s_mov_b32 s56, 360448
    buffer_load_dwordx4 v13, s[24:27], s56 offen lds
    s_mov_b32 m0, 118784
    s_mov_b32 s56, 393216
    buffer_load_dwordx4 v13, s[24:27], s56 offen lds
    s_mov_b32 m0, 119808
    s_mov_b32 s56, 425984
    buffer_load_dwordx4 v13, s[24:27], s56 offen lds
    s_mov_b32 m0, 120832
    s_mov_b32 s56, 458752
    buffer_load_dwordx4 v13, s[24:27], s56 offen lds
    s_mov_b32 m0, 121856
    s_mov_b32 s56, 491520
    buffer_load_dwordx4 v13, s[24:27], s56 offen lds
    s_mov_b32 m0, 122880
    s_mov_b32 s56, 524288
    buffer_load_dwordx4 v13, s[24:27], s56 offen lds
    s_mov_b32 m0, 123904
    s_mov_b32 s56, 557056
    buffer_load_dwordx4 v13, s[24:27], s56 offen lds
    s_mov_b32 m0, 124928
    s_mov_b32 s56, 589824
    buffer_load_dwordx4 v13, s[24:27], s56 offen lds
    s_mov_b32 m0, 125952
    s_mov_b32 s56, 622592
    buffer_load_dwordx4 v13, s[24:27], s56 offen lds
    s_mov_b32 m0, 126976
    s_mov_b32 s56, 655360
    buffer_load_dwordx4 v13, s[24:27], s56 offen lds
    s_mov_b32 m0, 128000
    s_mov_b32 s56, 688128
    buffer_load_dwordx4 v13, s[24:27], s56 offen lds
    s_mov_b32 m0, 129024
    s_mov_b32 s56, 720896
    buffer_load_dwordx4 v13, s[24:27], s56 offen lds
    s_mov_b32 m0, 130048
    s_mov_b32 s56, 753664
    buffer_load_dwordx4 v13, s[24:27], s56 offen lds
    s_mov_b32 m0, 131072
    s_mov_b32 s56, 786432
    buffer_load_dwordx4 v13, s[24:27], s56 offen lds
    s_mov_b32 m0, 132096
    s_mov_b32 s56, 819200
    buffer_load_dwordx4 v13, s[24:27], s56 offen lds
    s_mov_b32 m0, 133120
    s_mov_b32 s56, 851968
    buffer_load_dwordx4 v13, s[24:27], s56 offen lds
    s_mov_b32 m0, 134144
    s_mov_b32 s56, 884736
    buffer_load_dwordx4 v13, s[24:27], s56 offen lds
    s_mov_b32 m0, 135168
    s_mov_b32 s56, 917504
    buffer_load_dwordx4 v13, s[24:27], s56 offen lds
    s_mov_b32 m0, 136192
    s_mov_b32 s56, 950272
    buffer_load_dwordx4 v13, s[24:27], s56 offen lds
    s_mov_b32 m0, 137216
    s_mov_b32 s56, 983040
    buffer_load_dwordx4 v13, s[24:27], s56 offen lds
    s_mov_b32 m0, 138240
    s_mov_b32 s56, 1015808
    buffer_load_dwordx4 v13, s[24:27], s56 offen lds
    s_mov_b32 m0, 139264
    s_mov_b32 s56, 1048576
    buffer_load_dwordx4 v13, s[24:27], s56 offen lds
    s_mov_b32 m0, 140288
    s_mov_b32 s56, 1081344
    buffer_load_dwordx4 v13, s[24:27], s56 offen lds
    s_mov_b32 m0, 141312
    s_mov_b32 s56, 1114112
    buffer_load_dwordx4 v13, s[24:27], s56 offen lds
    s_mov_b32 m0, 142336
    s_mov_b32 s56, 1146880
    buffer_load_dwordx4 v13, s[24:27], s56 offen lds
    s_mov_b32 m0, 143360
    s_mov_b32 s56, 1179648
    buffer_load_dwordx4 v13, s[24:27], s56 offen lds
    s_mov_b32 m0, 144384
    s_mov_b32 s56, 1212416
    buffer_load_dwordx4 v13, s[24:27], s56 offen lds
    s_mov_b32 m0, 145408
    s_mov_b32 s56, 1245184
    buffer_load_dwordx4 v13, s[24:27], s56 offen lds
    s_mov_b32 m0, 146432
    s_mov_b32 s56, 1277952
    buffer_load_dwordx4 v13, s[24:27], s56 offen lds
    s_mov_b32 m0, 147456
    s_mov_b32 s56, 1310720
    buffer_load_dwordx4 v13, s[24:27], s56 offen lds
    s_mov_b32 m0, 148480
    s_mov_b32 s56, 1343488
    buffer_load_dwordx4 v13, s[24:27], s56 offen lds
    s_mov_b32 m0, 149504
    s_mov_b32 s56, 1376256
    buffer_load_dwordx4 v13, s[24:27], s56 offen lds
    s_mov_b32 m0, 150528
    s_mov_b32 s56, 1409024
    buffer_load_dwordx4 v13, s[24:27], s56 offen lds
    s_mov_b32 m0, 151552
    s_mov_b32 s56, 1441792
    buffer_load_dwordx4 v13, s[24:27], s56 offen lds
    s_mov_b32 m0, 152576
    s_mov_b32 s56, 1474560
    buffer_load_dwordx4 v13, s[24:27], s56 offen lds
    s_mov_b32 m0, 153600
    s_mov_b32 s56, 1507328
    buffer_load_dwordx4 v13, s[24:27], s56 offen lds
    s_mov_b32 m0, 154624
    s_mov_b32 s56, 1540096
    buffer_load_dwordx4 v13, s[24:27], s56 offen lds
    s_lshl_b32 s51, s2, 18
    s_add_u32 s16, s6, s51
    s_addc_u32 s17, s7, 0
    s_and_b32 s17, s17, 0xffff
    s_mov_b32 s18, 262144
    s_mov_b32 s19, 0x00020000
    s_add_u32 s20, s8, s51
    s_addc_u32 s21, s9, 0
    s_and_b32 s21, s21, 0xffff
    s_mov_b32 s22, 262144
    s_mov_b32 s23, 0x00020000
    s_lshl_b32 s51, s45, 17
    s_lshl_b32 s52, s44, 7
    s_add_u32 s51, s51, s52
    s_sub_u32 s52, 131072, s52
    s_add_u32 s36, s12, s51
    s_addc_u32 s37, s13, 0
    s_and_b32 s37, s37, 0xffff
    s_mov_b32 s38, s52
    s_mov_b32 s39, 0x00020000
    s_lshl_b32 s51, s44, 6
    s_add_u32 s51, s51, s45
    s_lshl_b32 s51, s51, 13
    s_add_u32 s51, s51, 16777216
    s_add_u32 s40, s14, s51
    s_addc_u32 s41, s15, 0
    s_and_b32 s41, s41, 0xffff
    s_mov_b32 s42, 270336
    s_mov_b32 s43, 0x00020000
    v_add_u32 v19, 0, v17
    v_xor_b32 v19, v19, v18
    v_lshlrev_b32 v19, 4, v19
    v_lshl_add_u32 v8, v17, 8, v19
    v_add_u32 v19, 4, v17
    v_xor_b32 v19, v19, v18
    v_lshlrev_b32 v19, 4, v19
    v_lshl_add_u32 v9, v17, 8, v19
    v_add_u32 v19, 8, v17
    v_xor_b32 v19, v19, v18
    v_lshlrev_b32 v19, 4, v19
    v_lshl_add_u32 v10, v17, 8, v19
    v_add_u32 v19, 12, v17
    v_xor_b32 v19, v19, v18
    v_lshlrev_b32 v19, 4, v19
    v_lshl_add_u32 v11, v17, 8, v19
    v_lshrrev_b32 v17, 3, v2
    v_and_b32 v18, 7, v2
    v_lshlrev_b32 v18, 4, v18
    v_lshl_add_u32 v14, v17, 10, v18
    v_and_b32 v17, 7, v2
    v_lshlrev_b32 v17, 2, v17
    v_add_u32 v15, 155680, v17
    v_mov_b32 v20, 155648
    v_lshrrev_b32 v17, 5, v2
    v_bfe_u32 v18, v2, 2, 2
    v_lshl_add_u32 v17, v17, 2, v18
    v_lshlrev_b32 v17, 7, v17
    v_bfe_u32 v18, v2, 4, 1
    v_lshl_add_u32 v17, v18, 5, v17
    v_and_b32 v18, 3, v2
    v_lshl_add_u32 v17, v18, 3, v17
    v_add_u32 v21, 131072, v17
    v_lshlrev_b32 v22, 2, v2
    v_add_u32 v22, 155648, v22
    v_mov_b32 v23, 0
    v_cmp_eq_u32 vcc, 15, v2
    v_mov_b32 v24, 0x7fffffff
    s_nop 1
    v_cndmask_b32 v23, v23, v24, vcc
    s_mov_b64 exec, 0xffff
    ds_write_b32 v22, v23
    s_mov_b64 exec, -1
    s_waitcnt lgkmcnt(0)
    s_barrier
    s_waitcnt vmcnt(40)
    s_mov_b64 exec, 1
    v_mov_b32 v17, 1
    ds_write_b32 v20, v17 offset:0
    s_mov_b64 exec, -1
    s_waitcnt vmcnt(32)
    s_mov_b64 exec, 1
    v_mov_b32 v17, 2
    ds_write_b32 v20, v17 offset:0
    s_mov_b64 exec, -1
    s_waitcnt vmcnt(24)
    s_mov_b64 exec, 1
    v_mov_b32 v17, 3
    ds_write_b32 v20, v17 offset:0
    s_mov_b64 exec, -1
    s_waitcnt vmcnt(16)
    s_mov_b64 exec, 1
    v_mov_b32 v17, 4
    ds_write_b32 v20, v17 offset:0
    s_mov_b64 exec, -1
    s_waitcnt vmcnt(8)
    s_mov_b64 exec, 1
    v_mov_b32 v17, 5
    ds_write_b32 v20, v17 offset:0
    s_mov_b64 exec, -1
    s_waitcnt vmcnt(0)
    s_mov_b64 exec, 1
    v_mov_b32 v17, 6
    ds_write_b32 v20, v17 offset:0
    s_mov_b64 exec, -1
L_pw_85:
    ds_read_b32 v16, v15
    s_waitcnt lgkmcnt(0)
    v_cmp_gt_u32 vcc, 1, v16
    s_cbranch_vccz L_pok_86
    s_sleep 2
    s_branch L_pw_85
L_pok_86:
    s_mov_b32 m0, 106496
    s_mov_b32 s56, 1572864
    buffer_load_dwordx4 v13, s[24:27], s56 offen lds
    s_mov_b32 m0, 107520
    s_mov_b32 s56, 1605632
    buffer_load_dwordx4 v13, s[24:27], s56 offen lds
    s_mov_b32 m0, 108544
    s_mov_b32 s56, 1638400
    buffer_load_dwordx4 v13, s[24:27], s56 offen lds
    s_mov_b32 m0, 109568
    s_mov_b32 s56, 1671168
    buffer_load_dwordx4 v13, s[24:27], s56 offen lds
    s_mov_b32 m0, 110592
    s_mov_b32 s56, 1703936
    buffer_load_dwordx4 v13, s[24:27], s56 offen lds
    s_mov_b32 m0, 111616
    s_mov_b32 s56, 1736704
    buffer_load_dwordx4 v13, s[24:27], s56 offen lds
    s_mov_b32 m0, 112640
    s_mov_b32 s56, 1769472
    buffer_load_dwordx4 v13, s[24:27], s56 offen lds
    s_mov_b32 m0, 113664
    s_mov_b32 s56, 1802240
    buffer_load_dwordx4 v13, s[24:27], s56 offen lds
L_pw_87:
    ds_read_b32 v16, v15
    s_waitcnt lgkmcnt(0)
    v_cmp_gt_u32 vcc, 2, v16
    s_cbranch_vccz L_pok_88
    s_sleep 2
    s_branch L_pw_87
L_pok_88:
    s_mov_b32 m0, 114688
    s_mov_b32 s56, 1835008
    buffer_load_dwordx4 v13, s[24:27], s56 offen lds
    s_mov_b32 m0, 115712
    s_mov_b32 s56, 1867776
    buffer_load_dwordx4 v13, s[24:27], s56 offen lds
    s_mov_b32 m0, 116736
    s_mov_b32 s56, 1900544
    buffer_load_dwordx4 v13, s[24:27], s56 offen lds
    s_mov_b32 m0, 117760
    s_mov_b32 s56, 1933312
    buffer_load_dwordx4 v13, s[24:27], s56 offen lds
    s_mov_b32 m0, 118784
    s_mov_b32 s56, 1966080
    buffer_load_dwordx4 v13, s[24:27], s56 offen lds
    s_mov_b32 m0, 119808
    s_mov_b32 s56, 1998848
    buffer_load_dwordx4 v13, s[24:27], s56 offen lds
    s_mov_b32 m0, 120832
    s_mov_b32 s56, 2031616
    buffer_load_dwordx4 v13, s[24:27], s56 offen lds
    s_mov_b32 m0, 121856
    s_mov_b32 s56, 2064384
    buffer_load_dwordx4 v13, s[24:27], s56 offen lds
L_pw_89:
    ds_read_b32 v16, v15
    s_waitcnt lgkmcnt(0)
    v_cmp_gt_u32 vcc, 3, v16
    s_cbranch_vccz L_pok_90
    s_sleep 2
    s_branch L_pw_89
L_pok_90:
    s_mov_b32 m0, 122880
    s_mov_b32 s56, 2097152
    buffer_load_dwordx4 v13, s[24:27], s56 offen lds
    s_mov_b32 m0, 123904
    s_mov_b32 s56, 2129920
    buffer_load_dwordx4 v13, s[24:27], s56 offen lds
    s_mov_b32 m0, 124928
    s_mov_b32 s56, 2162688
    buffer_load_dwordx4 v13, s[24:27], s56 offen lds
    s_mov_b32 m0, 125952
    s_mov_b32 s56, 2195456
    buffer_load_dwordx4 v13, s[24:27], s56 offen lds
    s_mov_b32 m0, 126976
    s_mov_b32 s56, 2228224
    buffer_load_dwordx4 v13, s[24:27], s56 offen lds
    s_mov_b32 m0, 128000
    s_mov_b32 s56, 2260992
    buffer_load_dwordx4 v13, s[24:27], s56 offen lds
    s_mov_b32 m0, 129024
    s_mov_b32 s56, 2293760
    buffer_load_dwordx4 v13, s[24:27], s56 offen lds
    s_mov_b32 m0, 130048
    s_mov_b32 s56, 2326528
    buffer_load_dwordx4 v13, s[24:27], s56 offen lds
L_pw_91:
    ds_read_b32 v16, v15
    s_waitcnt lgkmcnt(0)
    v_cmp_gt_u32 vcc, 4, v16
    s_cbranch_vccz L_pok_92
    s_sleep 2
    s_branch L_pw_91
L_pok_92:
    s_mov_b32 m0, 131072
    s_mov_b32 s56, 2359296
    buffer_load_dwordx4 v13, s[24:27], s56 offen lds
    s_mov_b32 m0, 132096
    s_mov_b32 s56, 2392064
    buffer_load_dwordx4 v13, s[24:27], s56 offen lds
    s_mov_b32 m0, 133120
    s_mov_b32 s56, 2424832
    buffer_load_dwordx4 v13, s[24:27], s56 offen lds
    s_mov_b32 m0, 134144
    s_mov_b32 s56, 2457600
    buffer_load_dwordx4 v13, s[24:27], s56 offen lds
    s_mov_b32 m0, 135168
    s_mov_b32 s56, 2490368
    buffer_load_dwordx4 v13, s[24:27], s56 offen lds
    s_mov_b32 m0, 136192
    s_mov_b32 s56, 2523136
    buffer_load_dwordx4 v13, s[24:27], s56 offen lds
    s_mov_b32 m0, 137216
    s_mov_b32 s56, 2555904
    buffer_load_dwordx4 v13, s[24:27], s56 offen lds
    s_mov_b32 m0, 138240
    s_mov_b32 s56, 2588672
    buffer_load_dwordx4 v13, s[24:27], s56 offen lds
    s_mov_b32 m0, 0
    s_mov_b32 s56, 0
    buffer_load_dwordx4 v8, s[16:19], s56 offen offset:0 nt lds
    buffer_load_dwordx4 v9, s[16:19], s56 offen offset:1024 nt lds
    buffer_load_dwordx4 v10, s[16:19], s56 offen offset:2048 nt lds
    buffer_load_dwordx4 v11, s[16:19], s56 offen offset:3072 nt lds
    s_mov_b32 m0, 4096
    s_mov_b32 s56, 4096
    buffer_load_dwordx4 v8, s[16:19], s56 offen offset:0 nt lds
    buffer_load_dwordx4 v9, s[16:19], s56 offen offset:1024 nt lds
    buffer_load_dwordx4 v10, s[16:19], s56 offen offset:2048 nt lds
    buffer_load_dwordx4 v11, s[16:19], s56 offen offset:3072 nt lds
    s_mov_b32 m0, 8192
    s_mov_b32 s56, 0
    buffer_load_dwordx4 v12, s[20:23], s56 offen offset:0 nt lds
    buffer_load_dwordx4 v12, s[20:23], s56 offen offset:1024 nt lds
    buffer_load_dwordx4 v12, s[20:23], s56 offen offset:2048 nt lds
    buffer_load_dwordx4 v12, s[20:23], s56 offen offset:3072 nt lds
    s_mov_b32 m0, 12288
    s_mov_b32 s56, 4096
    buffer_load_dwordx4 v12, s[20:23], s56 offen offset:0 nt lds
    buffer_load_dwordx4 v12, s[20:23], s56 offen offset:1024 nt lds
    buffer_load_dwordx4 v12, s[20:23], s56 offen offset:2048 nt lds
    buffer_load_dwordx4 v12, s[20:23], s56 offen offset:3072 nt lds
    s_waitcnt vmcnt(24)
    s_mov_b64 exec, 1
    v_mov_b32 v17, 9
    ds_write_b32 v20, v17 offset:0
    s_mov_b64 exec, -1
L_pw_93:
    ds_read_b32 v16, v15
    s_waitcnt lgkmcnt(0)
    v_cmp_gt_u32 vcc, 5, v16
    s_cbranch_vccz L_pok_94
    s_sleep 2
    s_branch L_pw_93
L_pok_94:
    s_mov_b32 m0, 139264
    s_mov_b32 s56, 2621440
    buffer_load_dwordx4 v13, s[24:27], s56 offen lds
    s_mov_b32 m0, 140288
    s_mov_b32 s56, 2654208
    buffer_load_dwordx4 v13, s[24:27], s56 offen lds
    s_mov_b32 m0, 141312
    s_mov_b32 s56, 2686976
    buffer_load_dwordx4 v13, s[24:27], s56 offen lds
    s_mov_b32 m0, 142336
    s_mov_b32 s56, 2719744
    buffer_load_dwordx4 v13, s[24:27], s56 offen lds
    s_mov_b32 m0, 143360
    s_mov_b32 s56, 2752512
    buffer_load_dwordx4 v13, s[24:27], s56 offen lds
    s_mov_b32 m0, 144384
    s_mov_b32 s56, 2785280
    buffer_load_dwordx4 v13, s[24:27], s56 offen lds
    s_mov_b32 m0, 145408
    s_mov_b32 s56, 2818048
    buffer_load_dwordx4 v13, s[24:27], s56 offen lds
    s_mov_b32 m0, 146432
    s_mov_b32 s56, 2850816
    buffer_load_dwordx4 v13, s[24:27], s56 offen lds
    s_waitcnt vmcnt(24)
    s_mov_b64 exec, 1
    v_mov_b32 v17, 10
    ds_write_b32 v20, v17 offset:0
    s_mov_b64 exec, -1
L_pw_95:
    ds_read_b32 v16, v15
    s_waitcnt lgkmcnt(0)
    v_cmp_gt_u32 vcc, 6, v16
    s_cbranch_vccz L_pok_96
    s_sleep 2
    s_branch L_pw_95
L_pok_96:
    s_mov_b32 m0, 147456
    s_mov_b32 s56, 2883584
    buffer_load_dwordx4 v13, s[24:27], s56 offen lds
    s_mov_b32 m0, 148480
    s_mov_b32 s56, 2916352
    buffer_load_dwordx4 v13, s[24:27], s56 offen lds
    s_mov_b32 m0, 149504
    s_mov_b32 s56, 2949120
    buffer_load_dwordx4 v13, s[24:27], s56 offen lds
    s_mov_b32 m0, 150528
    s_mov_b32 s56, 2981888
    buffer_load_dwordx4 v13, s[24:27], s56 offen lds
    s_mov_b32 m0, 151552
    s_mov_b32 s56, 3014656
    buffer_load_dwordx4 v13, s[24:27], s56 offen lds
    s_mov_b32 m0, 152576
    s_mov_b32 s56, 3047424
    buffer_load_dwordx4 v13, s[24:27], s56 offen lds
    s_mov_b32 m0, 153600
    s_mov_b32 s56, 3080192
    buffer_load_dwordx4 v13, s[24:27], s56 offen lds
    s_mov_b32 m0, 154624
    s_mov_b32 s56, 3112960
    buffer_load_dwordx4 v13, s[24:27], s56 offen lds
    s_waitcnt vmcnt(16)
    s_mov_b64 exec, 1
    v_mov_b32 v18, 1
    ds_write_b32 v20, v18 offset:4
    s_mov_b64 exec, -1
L_pw_97:
    ds_read_b32 v16, v15
    s_waitcnt lgkmcnt(0)
    v_cmp_gt_u32 vcc, 7, v16
    s_cbranch_vccz L_pok_98
    s_sleep 2
    s_branch L_pw_97
L_pok_98:
    s_mov_b32 m0, 106496
    s_mov_b32 s56, 3145728
    buffer_load_dwordx4 v13, s[24:27], s56 offen lds
    s_mov_b32 m0, 107520
    s_mov_b32 s56, 3178496
    buffer_load_dwordx4 v13, s[24:27], s56 offen lds
    s_mov_b32 m0, 108544
    s_mov_b32 s56, 3211264
    buffer_load_dwordx4 v13, s[24:27], s56 offen lds
    s_mov_b32 m0, 109568
    s_mov_b32 s56, 3244032
    buffer_load_dwordx4 v13, s[24:27], s56 offen lds
    s_mov_b32 m0, 110592
    s_mov_b32 s56, 3276800
    buffer_load_dwordx4 v13, s[24:27], s56 offen lds
    s_mov_b32 m0, 111616
    s_mov_b32 s56, 3309568
    buffer_load_dwordx4 v13, s[24:27], s56 offen lds
    s_mov_b32 m0, 112640
    s_mov_b32 s56, 3342336
    buffer_load_dwordx4 v13, s[24:27], s56 offen lds
    s_mov_b32 m0, 113664
    s_mov_b32 s56, 3375104
    buffer_load_dwordx4 v13, s[24:27], s56 offen lds
    s_mov_b32 m0, 16384
    s_mov_b32 s56, 8192
    buffer_load_dwordx4 v8, s[16:19], s56 offen offset:0 nt lds
    buffer_load_dwordx4 v9, s[16:19], s56 offen offset:1024 nt lds
    buffer_load_dwordx4 v10, s[16:19], s56 offen offset:2048 nt lds
    buffer_load_dwordx4 v11, s[16:19], s56 offen offset:3072 nt lds
    s_mov_b32 m0, 20480
    s_mov_b32 s56, 12288
    buffer_load_dwordx4 v8, s[16:19], s56 offen offset:0 nt lds
    buffer_load_dwordx4 v9, s[16:19], s56 offen offset:1024 nt lds
    buffer_load_dwordx4 v10, s[16:19], s56 offen offset:2048 nt lds
    buffer_load_dwordx4 v11, s[16:19], s56 offen offset:3072 nt lds
    s_mov_b32 m0, 24576
    s_mov_b32 s56, 8192
    buffer_load_dwordx4 v12, s[20:23], s56 offen offset:0 nt lds
    buffer_load_dwordx4 v12, s[20:23], s56 offen offset:1024 nt lds
    buffer_load_dwordx4 v12, s[20:23], s56 offen offset:2048 nt lds
    buffer_load_dwordx4 v12, s[20:23], s56 offen offset:3072 nt lds
    s_mov_b32 m0, 28672
    s_mov_b32 s56, 12288
    buffer_load_dwordx4 v12, s[20:23], s56 offen offset:0 nt lds
    buffer_load_dwordx4 v12, s[20:23], s56 offen offset:1024 nt lds
    buffer_load_dwordx4 v12, s[20:23], s56 offen offset:2048 nt lds
    buffer_load_dwordx4 v12, s[20:23], s56 offen offset:3072 nt lds
    s_waitcnt vmcnt(24)
    s_mov_b64 exec, 1
    v_mov_b32 v17, 12
    ds_write_b32 v20, v17 offset:0
    s_mov_b64 exec, -1
L_pw_99:
    ds_read_b32 v16, v15
    s_waitcnt lgkmcnt(0)
    v_cmp_gt_u32 vcc, 8, v16
    s_cbranch_vccz L_pok_100
    s_sleep 2
    s_branch L_pw_99
L_pok_100:
    s_mov_b32 m0, 114688
    s_mov_b32 s56, 3407872
    buffer_load_dwordx4 v13, s[24:27], s56 offen lds
    s_mov_b32 m0, 115712
    s_mov_b32 s56, 3440640
    buffer_load_dwordx4 v13, s[24:27], s56 offen lds
    s_mov_b32 m0, 116736
    s_mov_b32 s56, 3473408
    buffer_load_dwordx4 v13, s[24:27], s56 offen lds
    s_mov_b32 m0, 117760
    s_mov_b32 s56, 3506176
    buffer_load_dwordx4 v13, s[24:27], s56 offen lds
    s_mov_b32 m0, 118784
    s_mov_b32 s56, 3538944
    buffer_load_dwordx4 v13, s[24:27], s56 offen lds
    s_mov_b32 m0, 119808
    s_mov_b32 s56, 3571712
    buffer_load_dwordx4 v13, s[24:27], s56 offen lds
    s_mov_b32 m0, 120832
    s_mov_b32 s56, 3604480
    buffer_load_dwordx4 v13, s[24:27], s56 offen lds
    s_mov_b32 m0, 121856
    s_mov_b32 s56, 3637248
    buffer_load_dwordx4 v13, s[24:27], s56 offen lds
    s_waitcnt vmcnt(24)
    s_mov_b64 exec, 1
    v_mov_b32 v17, 13
    ds_write_b32 v20, v17 offset:0
    s_mov_b64 exec, -1
L_pw_101:
    ds_read_b32 v16, v15
    s_waitcnt lgkmcnt(0)
    v_cmp_gt_u32 vcc, 9, v16
    s_cbranch_vccz L_pok_102
    s_sleep 2
    s_branch L_pw_101
L_pok_102:
    s_mov_b32 m0, 122880
    s_mov_b32 s56, 3670016
    buffer_load_dwordx4 v13, s[24:27], s56 offen lds
    s_mov_b32 m0, 123904
    s_mov_b32 s56, 3702784
    buffer_load_dwordx4 v13, s[24:27], s56 offen lds
    s_mov_b32 m0, 124928
    s_mov_b32 s56, 3735552
    buffer_load_dwordx4 v13, s[24:27], s56 offen lds
    s_mov_b32 m0, 125952
    s_mov_b32 s56, 3768320
    buffer_load_dwordx4 v13, s[24:27], s56 offen lds
    s_mov_b32 m0, 126976
    s_mov_b32 s56, 3801088
    buffer_load_dwordx4 v13, s[24:27], s56 offen lds
    s_mov_b32 m0, 128000
    s_mov_b32 s56, 3833856
    buffer_load_dwordx4 v13, s[24:27], s56 offen lds
    s_mov_b32 m0, 129024
    s_mov_b32 s56, 3866624
    buffer_load_dwordx4 v13, s[24:27], s56 offen lds
    s_mov_b32 m0, 130048
    s_mov_b32 s56, 3899392
    buffer_load_dwordx4 v13, s[24:27], s56 offen lds
    s_waitcnt vmcnt(16)
    s_mov_b64 exec, 1
    v_mov_b32 v18, 2
    ds_write_b32 v20, v18 offset:4
    s_mov_b64 exec, -1
L_pw_103:
    ds_read_b32 v16, v15
    s_waitcnt lgkmcnt(0)
    v_cmp_gt_u32 vcc, 10, v16
    s_cbranch_vccz L_pok_104
    s_sleep 2
    s_branch L_pw_103
L_pok_104:
    s_mov_b32 m0, 131072
    s_mov_b32 s56, 3932160
    buffer_load_dwordx4 v13, s[24:27], s56 offen lds
    s_mov_b32 m0, 132096
    s_mov_b32 s56, 3964928
    buffer_load_dwordx4 v13, s[24:27], s56 offen lds
    s_mov_b32 m0, 133120
    s_mov_b32 s56, 3997696
    buffer_load_dwordx4 v13, s[24:27], s56 offen lds
    s_mov_b32 m0, 134144
    s_mov_b32 s56, 4030464
    buffer_load_dwordx4 v13, s[24:27], s56 offen lds
    s_mov_b32 m0, 135168
    s_mov_b32 s56, 4063232
    buffer_load_dwordx4 v13, s[24:27], s56 offen lds
    s_mov_b32 m0, 136192
    s_mov_b32 s56, 4096000
    buffer_load_dwordx4 v13, s[24:27], s56 offen lds
    s_mov_b32 m0, 137216
    s_mov_b32 s56, 4128768
    buffer_load_dwordx4 v13, s[24:27], s56 offen lds
    s_mov_b32 m0, 138240
    s_mov_b32 s56, 4161536
    buffer_load_dwordx4 v13, s[24:27], s56 offen lds
    s_mov_b32 m0, 32768
    s_mov_b32 s56, 16384
    buffer_load_dwordx4 v8, s[16:19], s56 offen offset:0 nt lds
    buffer_load_dwordx4 v9, s[16:19], s56 offen offset:1024 nt lds
    buffer_load_dwordx4 v10, s[16:19], s56 offen offset:2048 nt lds
    buffer_load_dwordx4 v11, s[16:19], s56 offen offset:3072 nt lds
    s_mov_b32 m0, 36864
    s_mov_b32 s56, 20480
    buffer_load_dwordx4 v8, s[16:19], s56 offen offset:0 nt lds
    buffer_load_dwordx4 v9, s[16:19], s56 offen offset:1024 nt lds
    buffer_load_dwordx4 v10, s[16:19], s56 offen offset:2048 nt lds
    buffer_load_dwordx4 v11, s[16:19], s56 offen offset:3072 nt lds
    s_mov_b32 m0, 40960
    s_mov_b32 s56, 16384
    buffer_load_dwordx4 v12, s[20:23], s56 offen offset:0 nt lds
    buffer_load_dwordx4 v12, s[20:23], s56 offen offset:1024 nt lds
    buffer_load_dwordx4 v12, s[20:23], s56 offen offset:2048 nt lds
    buffer_load_dwordx4 v12, s[20:23], s56 offen offset:3072 nt lds
    s_mov_b32 m0, 45056
    s_mov_b32 s56, 20480
    buffer_load_dwordx4 v12, s[20:23], s56 offen offset:0 nt lds
    buffer_load_dwordx4 v12, s[20:23], s56 offen offset:1024 nt lds
    buffer_load_dwordx4 v12, s[20:23], s56 offen offset:2048 nt lds
    buffer_load_dwordx4 v12, s[20:23], s56 offen offset:3072 nt lds
    s_waitcnt vmcnt(24)
    s_mov_b64 exec, 1
    v_mov_b32 v17, 15
    ds_write_b32 v20, v17 offset:0
    s_mov_b64 exec, -1
    s_waitcnt vmcnt(16)
    s_mov_b64 exec, 1
    v_mov_b32 v17, 16
    ds_write_b32 v20, v17 offset:0
    s_mov_b64 exec, -1
L_pw_105:
    ds_read_b32 v16, v15
    s_waitcnt lgkmcnt(0)
    v_cmp_gt_u32 vcc, 16, v16
    s_cbranch_vccz L_pok_106
    s_sleep 2
    s_branch L_pw_105
L_pok_106:
    s_mov_b32 m0, 49152
    s_mov_b32 s56, 24576
    buffer_load_dwordx4 v8, s[16:19], s56 offen offset:0 nt lds
    buffer_load_dwordx4 v9, s[16:19], s56 offen offset:1024 nt lds
    buffer_load_dwordx4 v10, s[16:19], s56 offen offset:2048 nt lds
    buffer_load_dwordx4 v11, s[16:19], s56 offen offset:3072 nt lds
    s_mov_b32 m0, 53248
    s_mov_b32 s56, 28672
    buffer_load_dwordx4 v8, s[16:19], s56 offen offset:0 nt lds
    buffer_load_dwordx4 v9, s[16:19], s56 offen offset:1024 nt lds
    buffer_load_dwordx4 v10, s[16:19], s56 offen offset:2048 nt lds
    buffer_load_dwordx4 v11, s[16:19], s56 offen offset:3072 nt lds
    s_mov_b32 m0, 57344
    s_mov_b32 s56, 24576
    buffer_load_dwordx4 v12, s[20:23], s56 offen offset:0 nt lds
    buffer_load_dwordx4 v12, s[20:23], s56 offen offset:1024 nt lds
    buffer_load_dwordx4 v12, s[20:23], s56 offen offset:2048 nt lds
    buffer_load_dwordx4 v12, s[20:23], s56 offen offset:3072 nt lds
    s_mov_b32 m0, 61440
    s_mov_b32 s56, 28672
    buffer_load_dwordx4 v12, s[20:23], s56 offen offset:0 nt lds
    buffer_load_dwordx4 v12, s[20:23], s56 offen offset:1024 nt lds
    buffer_load_dwordx4 v12, s[20:23], s56 offen offset:2048 nt lds
    buffer_load_dwordx4 v12, s[20:23], s56 offen offset:3072 nt lds
L_pw_107:
    ds_read_b32 v16, v15
    s_waitcnt lgkmcnt(0)
    v_cmp_gt_u32 vcc, 16, v16
    s_cbranch_vccz L_pok_108
    s_sleep 2
    s_branch L_pw_107
L_pok_108:
    s_mov_b32 m0, 65536
    s_mov_b32 s56, 32768
    buffer_load_dwordx4 v8, s[16:19], s56 offen offset:0 nt lds
    buffer_load_dwordx4 v9, s[16:19], s56 offen offset:1024 nt lds
    buffer_load_dwordx4 v10, s[16:19], s56 offen offset:2048 nt lds
    buffer_load_dwordx4 v11, s[16:19], s56 offen offset:3072 nt lds
    s_mov_b32 m0, 69632
    s_mov_b32 s56, 36864
    buffer_load_dwordx4 v8, s[16:19], s56 offen offset:0 nt lds
    buffer_load_dwordx4 v9, s[16:19], s56 offen offset:1024 nt lds
    buffer_load_dwordx4 v10, s[16:19], s56 offen offset:2048 nt lds
    buffer_load_dwordx4 v11, s[16:19], s56 offen offset:3072 nt lds
    s_mov_b32 m0, 73728
    s_mov_b32 s56, 32768
    buffer_load_dwordx4 v12, s[20:23], s56 offen offset:0 nt lds
    buffer_load_dwordx4 v12, s[20:23], s56 offen offset:1024 nt lds
    buffer_load_dwordx4 v12, s[20:23], s56 offen offset:2048 nt lds
    buffer_load_dwordx4 v12, s[20:23], s56 offen offset:3072 nt lds
    s_mov_b32 m0, 77824
    s_mov_b32 s56, 36864
    buffer_load_dwordx4 v12, s[20:23], s56 offen offset:0 nt lds
    buffer_load_dwordx4 v12, s[20:23], s56 offen offset:1024 nt lds
    buffer_load_dwordx4 v12, s[20:23], s56 offen offset:2048 nt lds
    buffer_load_dwordx4 v12, s[20:23], s56 offen offset:3072 nt lds
    s_waitcnt vmcnt(32)
    s_mov_b64 exec, 1
    v_mov_b32 v18, 3
    ds_write_b32 v20, v18 offset:4
    s_mov_b64 exec, -1
L_pw_109:
    ds_read_b32 v16, v15
    s_waitcnt lgkmcnt(0)
    v_cmp_gt_u32 vcc, 16, v16
    s_cbranch_vccz L_pok_110
    s_sleep 2
    s_branch L_pw_109
L_pok_110:
    s_mov_b32 m0, 81920
    s_mov_b32 s56, 40960
    buffer_load_dwordx4 v8, s[16:19], s56 offen offset:0 nt lds
    buffer_load_dwordx4 v9, s[16:19], s56 offen offset:1024 nt lds
    buffer_load_dwordx4 v10, s[16:19], s56 offen offset:2048 nt lds
    buffer_load_dwordx4 v11, s[16:19], s56 offen offset:3072 nt lds
    s_mov_b32 m0, 86016
    s_mov_b32 s56, 45056
    buffer_load_dwordx4 v8, s[16:19], s56 offen offset:0 nt lds
    buffer_load_dwordx4 v9, s[16:19], s56 offen offset:1024 nt lds
    buffer_load_dwordx4 v10, s[16:19], s56 offen offset:2048 nt lds
    buffer_load_dwordx4 v11, s[16:19], s56 offen offset:3072 nt lds
    s_mov_b32 m0, 90112
    s_mov_b32 s56, 40960
    buffer_load_dwordx4 v12, s[20:23], s56 offen offset:0 nt lds
    buffer_load_dwordx4 v12, s[20:23], s56 offen offset:1024 nt lds
    buffer_load_dwordx4 v12, s[20:23], s56 offen offset:2048 nt lds
    buffer_load_dwordx4 v12, s[20:23], s56 offen offset:3072 nt lds
    s_mov_b32 m0, 94208
    s_mov_b32 s56, 45056
    buffer_load_dwordx4 v12, s[20:23], s56 offen offset:0 nt lds
    buffer_load_dwordx4 v12, s[20:23], s56 offen offset:1024 nt lds
    buffer_load_dwordx4 v12, s[20:23], s56 offen offset:2048 nt lds
    buffer_load_dwordx4 v12, s[20:23], s56 offen offset:3072 nt lds
    s_waitcnt vmcnt(32)
    s_mov_b64 exec, 1
    v_mov_b32 v18, 4
    ds_write_b32 v20, v18 offset:4
    s_mov_b64 exec, -1
L_pw_111:
    ds_read_b32 v16, v15
    s_waitcnt lgkmcnt(0)
    v_cmp_gt_u32 vcc, 16, v16
    s_cbranch_vccz L_pok_112
    s_sleep 2
    s_branch L_pw_111
L_pok_112:
    s_mov_b32 m0, 98304
    s_mov_b32 s56, 49152
    buffer_load_dwordx4 v8, s[16:19], s56 offen offset:0 nt lds
    buffer_load_dwordx4 v9, s[16:19], s56 offen offset:1024 nt lds
    buffer_load_dwordx4 v10, s[16:19], s56 offen offset:2048 nt lds
    buffer_load_dwordx4 v11, s[16:19], s56 offen offset:3072 nt lds
    s_mov_b32 m0, 102400
    s_mov_b32 s56, 53248
    buffer_load_dwordx4 v8, s[16:19], s56 offen offset:0 nt lds
    buffer_load_dwordx4 v9, s[16:19], s56 offen offset:1024 nt lds
    buffer_load_dwordx4 v10, s[16:19], s56 offen offset:2048 nt lds
    buffer_load_dwordx4 v11, s[16:19], s56 offen offset:3072 nt lds
    s_mov_b32 m0, 106496
    s_mov_b32 s56, 49152
    buffer_load_dwordx4 v12, s[20:23], s56 offen offset:0 nt lds
    buffer_load_dwordx4 v12, s[20:23], s56 offen offset:1024 nt lds
    buffer_load_dwordx4 v12, s[20:23], s56 offen offset:2048 nt lds
    buffer_load_dwordx4 v12, s[20:23], s56 offen offset:3072 nt lds
    s_mov_b32 m0, 110592
    s_mov_b32 s56, 53248
    buffer_load_dwordx4 v12, s[20:23], s56 offen offset:0 nt lds
    buffer_load_dwordx4 v12, s[20:23], s56 offen offset:1024 nt lds
    buffer_load_dwordx4 v12, s[20:23], s56 offen offset:2048 nt lds
    buffer_load_dwordx4 v12, s[20:23], s56 offen offset:3072 nt lds
    s_waitcnt vmcnt(32)
    s_mov_b64 exec, 1
    v_mov_b32 v18, 5
    ds_write_b32 v20, v18 offset:4
    s_mov_b64 exec, -1
L_pw_113:
    ds_read_b32 v16, v15
    s_waitcnt lgkmcnt(0)
    v_cmp_gt_u32 vcc, 16, v16
    s_cbranch_vccz L_pok_114
    s_sleep 2
    s_branch L_pw_113
L_pok_114:
    s_mov_b32 m0, 114688
    s_mov_b32 s56, 57344
    buffer_load_dwordx4 v8, s[16:19], s56 offen offset:0 nt lds
    buffer_load_dwordx4 v9, s[16:19], s56 offen offset:1024 nt lds
    buffer_load_dwordx4 v10, s[16:19], s56 offen offset:2048 nt lds
    buffer_load_dwordx4 v11, s[16:19], s56 offen offset:3072 nt lds
    s_mov_b32 m0, 118784
    s_mov_b32 s56, 61440
    buffer_load_dwordx4 v8, s[16:19], s56 offen offset:0 nt lds
    buffer_load_dwordx4 v9, s[16:19], s56 offen offset:1024 nt lds
    buffer_load_dwordx4 v10, s[16:19], s56 offen offset:2048 nt lds
    buffer_load_dwordx4 v11, s[16:19], s56 offen offset:3072 nt lds
    s_mov_b32 m0, 122880
    s_mov_b32 s56, 57344
    buffer_load_dwordx4 v12, s[20:23], s56 offen offset:0 nt lds
    buffer_load_dwordx4 v12, s[20:23], s56 offen offset:1024 nt lds
    buffer_load_dwordx4 v12, s[20:23], s56 offen offset:2048 nt lds
    buffer_load_dwordx4 v12, s[20:23], s56 offen offset:3072 nt lds
    s_mov_b32 m0, 126976
    s_mov_b32 s56, 61440
    buffer_load_dwordx4 v12, s[20:23], s56 offen offset:0 nt lds
    buffer_load_dwordx4 v12, s[20:23], s56 offen offset:1024 nt lds
    buffer_load_dwordx4 v12, s[20:23], s56 offen offset:2048 nt lds
    buffer_load_dwordx4 v12, s[20:23], s56 offen offset:3072 nt lds
    s_waitcnt vmcnt(32)
    s_mov_b64 exec, 1
    v_mov_b32 v18, 6
    ds_write_b32 v20, v18 offset:4
    s_mov_b64 exec, -1
L_pw_115:
    ds_read_b32 v16, v15
    s_waitcnt lgkmcnt(0)
    v_cmp_gt_u32 vcc, 17, v16
    s_cbranch_vccz L_pok_116
    s_sleep 2
    s_branch L_pw_115
L_pok_116:
    s_mov_b32 m0, 0
    s_mov_b32 s56, 65536
    buffer_load_dwordx4 v8, s[16:19], s56 offen offset:0 nt lds
    buffer_load_dwordx4 v9, s[16:19], s56 offen offset:1024 nt lds
    buffer_load_dwordx4 v10, s[16:19], s56 offen offset:2048 nt lds
    buffer_load_dwordx4 v11, s[16:19], s56 offen offset:3072 nt lds
    s_mov_b32 m0, 4096
    s_mov_b32 s56, 69632
    buffer_load_dwordx4 v8, s[16:19], s56 offen offset:0 nt lds
    buffer_load_dwordx4 v9, s[16:19], s56 offen offset:1024 nt lds
    buffer_load_dwordx4 v10, s[16:19], s56 offen offset:2048 nt lds
    buffer_load_dwordx4 v11, s[16:19], s56 offen offset:3072 nt lds
    s_mov_b32 m0, 8192
    s_mov_b32 s56, 65536
    buffer_load_dwordx4 v12, s[20:23], s56 offen offset:0 nt lds
    buffer_load_dwordx4 v12, s[20:23], s56 offen offset:1024 nt lds
    buffer_load_dwordx4 v12, s[20:23], s56 offen offset:2048 nt lds
    buffer_load_dwordx4 v12, s[20:23], s56 offen offset:3072 nt lds
    s_mov_b32 m0, 12288
    s_mov_b32 s56, 69632
    buffer_load_dwordx4 v12, s[20:23], s56 offen offset:0 nt lds
    buffer_load_dwordx4 v12, s[20:23], s56 offen offset:1024 nt lds
    buffer_load_dwordx4 v12, s[20:23], s56 offen offset:2048 nt lds
    buffer_load_dwordx4 v12, s[20:23], s56 offen offset:3072 nt lds
    s_waitcnt vmcnt(32)
    s_mov_b64 exec, 1
    v_mov_b32 v18, 7
    ds_write_b32 v20, v18 offset:4
    s_mov_b64 exec, -1
L_pw_117:
    ds_read_b32 v16, v15
    s_waitcnt lgkmcnt(0)
    v_cmp_gt_u32 vcc, 18, v16
    s_cbranch_vccz L_pok_118
    s_sleep 2
    s_branch L_pw_117
L_pok_118:
    s_mov_b32 m0, 16384
    s_mov_b32 s56, 73728
    buffer_load_dwordx4 v8, s[16:19], s56 offen offset:0 nt lds
    buffer_load_dwordx4 v9, s[16:19], s56 offen offset:1024 nt lds
    buffer_load_dwordx4 v10, s[16:19], s56 offen offset:2048 nt lds
    buffer_load_dwordx4 v11, s[16:19], s56 offen offset:3072 nt lds
    s_mov_b32 m0, 20480
    s_mov_b32 s56, 77824
    buffer_load_dwordx4 v8, s[16:19], s56 offen offset:0 nt lds
    buffer_load_dwordx4 v9, s[16:19], s56 offen offset:1024 nt lds
    buffer_load_dwordx4 v10, s[16:19], s56 offen offset:2048 nt lds
    buffer_load_dwordx4 v11, s[16:19], s56 offen offset:3072 nt lds
    s_mov_b32 m0, 24576
    s_mov_b32 s56, 73728
    buffer_load_dwordx4 v12, s[20:23], s56 offen offset:0 nt lds
    buffer_load_dwordx4 v12, s[20:23], s56 offen offset:1024 nt lds
    buffer_load_dwordx4 v12, s[20:23], s56 offen offset:2048 nt lds
    buffer_load_dwordx4 v12, s[20:23], s56 offen offset:3072 nt lds
    s_mov_b32 m0, 28672
    s_mov_b32 s56, 77824
    buffer_load_dwordx4 v12, s[20:23], s56 offen offset:0 nt lds
    buffer_load_dwordx4 v12, s[20:23], s56 offen offset:1024 nt lds
    buffer_load_dwordx4 v12, s[20:23], s56 offen offset:2048 nt lds
    buffer_load_dwordx4 v12, s[20:23], s56 offen offset:3072 nt lds
    s_waitcnt vmcnt(32)
    s_mov_b64 exec, 1
    v_mov_b32 v18, 8
    ds_write_b32 v20, v18 offset:4
    s_mov_b64 exec, -1
L_pw_119:
    ds_read_b32 v16, v15
    s_waitcnt lgkmcnt(0)
    v_cmp_gt_u32 vcc, 19, v16
    s_cbranch_vccz L_pok_120
    s_sleep 2
    s_branch L_pw_119
L_pok_120:
    s_mov_b32 m0, 32768
    s_mov_b32 s56, 81920
    buffer_load_dwordx4 v8, s[16:19], s56 offen offset:0 nt lds
    buffer_load_dwordx4 v9, s[16:19], s56 offen offset:1024 nt lds
    buffer_load_dwordx4 v10, s[16:19], s56 offen offset:2048 nt lds
    buffer_load_dwordx4 v11, s[16:19], s56 offen offset:3072 nt lds
    s_mov_b32 m0, 36864
    s_mov_b32 s56, 86016
    buffer_load_dwordx4 v8, s[16:19], s56 offen offset:0 nt lds
    buffer_load_dwordx4 v9, s[16:19], s56 offen offset:1024 nt lds
    buffer_load_dwordx4 v10, s[16:19], s56 offen offset:2048 nt lds
    buffer_load_dwordx4 v11, s[16:19], s56 offen offset:3072 nt lds
    s_mov_b32 m0, 40960
    s_mov_b32 s56, 81920
    buffer_load_dwordx4 v12, s[20:23], s56 offen offset:0 nt lds
    buffer_load_dwordx4 v12, s[20:23], s56 offen offset:1024 nt lds
    buffer_load_dwordx4 v12, s[20:23], s56 offen offset:2048 nt lds
    buffer_load_dwordx4 v12, s[20:23], s56 offen offset:3072 nt lds
    s_mov_b32 m0, 45056
    s_mov_b32 s56, 86016
    buffer_load_dwordx4 v12, s[20:23], s56 offen offset:0 nt lds
    buffer_load_dwordx4 v12, s[20:23], s56 offen offset:1024 nt lds
    buffer_load_dwordx4 v12, s[20:23], s56 offen offset:2048 nt lds
    buffer_load_dwordx4 v12, s[20:23], s56 offen offset:3072 nt lds
    s_waitcnt vmcnt(32)
    s_mov_b64 exec, 1
    v_mov_b32 v18, 9
    ds_write_b32 v20, v18 offset:4
    s_mov_b64 exec, -1
L_pw_121:
    ds_read_b32 v16, v15
    s_waitcnt lgkmcnt(0)
    v_cmp_gt_u32 vcc, 20, v16
    s_cbranch_vccz L_pok_122
    s_sleep 2
    s_branch L_pw_121
L_pok_122:
    s_mov_b32 m0, 49152
    s_mov_b32 s56, 90112
    buffer_load_dwordx4 v8, s[16:19], s56 offen offset:0 nt lds
    buffer_load_dwordx4 v9, s[16:19], s56 offen offset:1024 nt lds
    buffer_load_dwordx4 v10, s[16:19], s56 offen offset:2048 nt lds
    buffer_load_dwordx4 v11, s[16:19], s56 offen offset:3072 nt lds
    s_mov_b32 m0, 53248
    s_mov_b32 s56, 94208
    buffer_load_dwordx4 v8, s[16:19], s56 offen offset:0 nt lds
    buffer_load_dwordx4 v9, s[16:19], s56 offen offset:1024 nt lds
    buffer_load_dwordx4 v10, s[16:19], s56 offen offset:2048 nt lds
    buffer_load_dwordx4 v11, s[16:19], s56 offen offset:3072 nt lds
    s_mov_b32 m0, 57344
    s_mov_b32 s56, 90112
    buffer_load_dwordx4 v12, s[20:23], s56 offen offset:0 nt lds
    buffer_load_dwordx4 v12, s[20:23], s56 offen offset:1024 nt lds
    buffer_load_dwordx4 v12, s[20:23], s56 offen offset:2048 nt lds
    buffer_load_dwordx4 v12, s[20:23], s56 offen offset:3072 nt lds
    s_mov_b32 m0, 61440
    s_mov_b32 s56, 94208
    buffer_load_dwordx4 v12, s[20:23], s56 offen offset:0 nt lds
    buffer_load_dwordx4 v12, s[20:23], s56 offen offset:1024 nt lds
    buffer_load_dwordx4 v12, s[20:23], s56 offen offset:2048 nt lds
    buffer_load_dwordx4 v12, s[20:23], s56 offen offset:3072 nt lds
    s_waitcnt vmcnt(32)
    s_mov_b64 exec, 1
    v_mov_b32 v18, 10
    ds_write_b32 v20, v18 offset:4
    s_mov_b64 exec, -1
L_pw_123:
    ds_read_b32 v16, v15
    s_waitcnt lgkmcnt(0)
    v_cmp_gt_u32 vcc, 21, v16
    s_cbranch_vccz L_pok_124
    s_sleep 2
    s_branch L_pw_123
L_pok_124:
    s_mov_b32 m0, 65536
    s_mov_b32 s56, 98304
    buffer_load_dwordx4 v8, s[16:19], s56 offen offset:0 nt lds
    buffer_load_dwordx4 v9, s[16:19], s56 offen offset:1024 nt lds
    buffer_load_dwordx4 v10, s[16:19], s56 offen offset:2048 nt lds
    buffer_load_dwordx4 v11, s[16:19], s56 offen offset:3072 nt lds
    s_mov_b32 m0, 69632
    s_mov_b32 s56, 102400
    buffer_load_dwordx4 v8, s[16:19], s56 offen offset:0 nt lds
    buffer_load_dwordx4 v9, s[16:19], s56 offen offset:1024 nt lds
    buffer_load_dwordx4 v10, s[16:19], s56 offen offset:2048 nt lds
    buffer_load_dwordx4 v11, s[16:19], s56 offen offset:3072 nt lds
    s_mov_b32 m0, 73728
    s_mov_b32 s56, 98304
    buffer_load_dwordx4 v12, s[20:23], s56 offen offset:0 nt lds
    buffer_load_dwordx4 v12, s[20:23], s56 offen offset:1024 nt lds
    buffer_load_dwordx4 v12, s[20:23], s56 offen offset:2048 nt lds
    buffer_load_dwordx4 v12, s[20:23], s56 offen offset:3072 nt lds
    s_mov_b32 m0, 77824
    s_mov_b32 s56, 102400
    buffer_load_dwordx4 v12, s[20:23], s56 offen offset:0 nt lds
    buffer_load_dwordx4 v12, s[20:23], s56 offen offset:1024 nt lds
    buffer_load_dwordx4 v12, s[20:23], s56 offen offset:2048 nt lds
    buffer_load_dwordx4 v12, s[20:23], s56 offen offset:3072 nt lds
    s_waitcnt vmcnt(32)
    s_mov_b64 exec, 1
    v_mov_b32 v18, 11
    ds_write_b32 v20, v18 offset:4
    s_mov_b64 exec, -1
    s_mov_b32 m0, 131072
    s_mov_b32 s56, 0
    buffer_load_dwordx4 v14, s[36:39], s56 offen lds
    s_mov_b32 m0, 132096
    s_mov_b32 s56, 8192
    buffer_load_dwordx4 v14, s[36:39], s56 offen lds
    s_mov_b32 m0, 133120
    s_mov_b32 s56, 16384
    buffer_load_dwordx4 v14, s[36:39], s56 offen lds
    s_mov_b32 m0, 134144
    s_mov_b32 s56, 24576
    buffer_load_dwordx4 v14, s[36:39], s56 offen lds
    s_mov_b32 m0, 135168
    s_mov_b32 s56, 32768
    buffer_load_dwordx4 v14, s[36:39], s56 offen lds
    s_mov_b32 m0, 136192
    s_mov_b32 s56, 40960
    buffer_load_dwordx4 v14, s[36:39], s56 offen lds
    s_mov_b32 m0, 137216
    s_mov_b32 s56, 49152
    buffer_load_dwordx4 v14, s[36:39], s56 offen lds
    s_mov_b32 m0, 138240
    s_mov_b32 s56, 57344
    buffer_load_dwordx4 v14, s[36:39], s56 offen lds
    s_mov_b32 m0, 139264
    s_mov_b32 s56, 65536
    buffer_load_dwordx4 v14, s[36:39], s56 offen lds
    s_mov_b32 m0, 140288
    s_mov_b32 s56, 73728
    buffer_load_dwordx4 v14, s[36:39], s56 offen lds
    s_mov_b32 m0, 141312
    s_mov_b32 s56, 81920
    buffer_load_dwordx4 v14, s[36:39], s56 offen lds
    s_mov_b32 m0, 142336
    s_mov_b32 s56, 90112
    buffer_load_dwordx4 v14, s[36:39], s56 offen lds
    s_mov_b32 m0, 143360
    s_mov_b32 s56, 98304
    buffer_load_dwordx4 v14, s[36:39], s56 offen lds
    s_mov_b32 m0, 144384
    s_mov_b32 s56, 106496
    buffer_load_dwordx4 v14, s[36:39], s56 offen lds
    s_mov_b32 m0, 145408
    s_mov_b32 s56, 114688
    buffer_load_dwordx4 v14, s[36:39], s56 offen lds
    s_mov_b32 m0, 146432
    s_mov_b32 s56, 122880
    buffer_load_dwordx4 v14, s[36:39], s56 offen lds
    s_waitcnt vmcnt(32)
    s_mov_b64 exec, 1
    v_mov_b32 v18, 12
    ds_write_b32 v20, v18 offset:4
    s_mov_b64 exec, -1
L_pw_125:
    ds_read_b32 v16, v15
    s_waitcnt lgkmcnt(0)
    v_cmp_gt_u32 vcc, 22, v16
    s_cbranch_vccz L_pok_126
    s_sleep 2
    s_branch L_pw_125
L_pok_126:
    s_mov_b32 m0, 81920
    s_mov_b32 s56, 106496
    buffer_load_dwordx4 v8, s[16:19], s56 offen offset:0 nt lds
    buffer_load_dwordx4 v9, s[16:19], s56 offen offset:1024 nt lds
    buffer_load_dwordx4 v10, s[16:19], s56 offen offset:2048 nt lds
    buffer_load_dwordx4 v11, s[16:19], s56 offen offset:3072 nt lds
    s_mov_b32 m0, 86016
    s_mov_b32 s56, 110592
    buffer_load_dwordx4 v8, s[16:19], s56 offen offset:0 nt lds
    buffer_load_dwordx4 v9, s[16:19], s56 offen offset:1024 nt lds
    buffer_load_dwordx4 v10, s[16:19], s56 offen offset:2048 nt lds
    buffer_load_dwordx4 v11, s[16:19], s56 offen offset:3072 nt lds
    s_mov_b32 m0, 90112
    s_mov_b32 s56, 106496
    buffer_load_dwordx4 v12, s[20:23], s56 offen offset:0 nt lds
    buffer_load_dwordx4 v12, s[20:23], s56 offen offset:1024 nt lds
    buffer_load_dwordx4 v12, s[20:23], s56 offen offset:2048 nt lds
    buffer_load_dwordx4 v12, s[20:23], s56 offen offset:3072 nt lds
    s_mov_b32 m0, 94208
    s_mov_b32 s56, 110592
    buffer_load_dwordx4 v12, s[20:23], s56 offen offset:0 nt lds
    buffer_load_dwordx4 v12, s[20:23], s56 offen offset:1024 nt lds
    buffer_load_dwordx4 v12, s[20:23], s56 offen offset:2048 nt lds
    buffer_load_dwordx4 v12, s[20:23], s56 offen offset:3072 nt lds
    s_waitcnt vmcnt(32)
    s_mov_b64 exec, 1
    v_mov_b32 v18, 13
    ds_write_b32 v20, v18 offset:4
    s_mov_b64 exec, -1
L_pw_127:
    ds_read_b32 v16, v15
    s_waitcnt lgkmcnt(0)
    v_cmp_gt_u32 vcc, 23, v16
    s_cbranch_vccz L_pok_128
    s_sleep 2
    s_branch L_pw_127
L_pok_128:
    s_mov_b32 m0, 98304
    s_mov_b32 s56, 114688
    buffer_load_dwordx4 v8, s[16:19], s56 offen offset:0 nt lds
    buffer_load_dwordx4 v9, s[16:19], s56 offen offset:1024 nt lds
    buffer_load_dwordx4 v10, s[16:19], s56 offen offset:2048 nt lds
    buffer_load_dwordx4 v11, s[16:19], s56 offen offset:3072 nt lds
    s_mov_b32 m0, 102400
    s_mov_b32 s56, 118784
    buffer_load_dwordx4 v8, s[16:19], s56 offen offset:0 nt lds
    buffer_load_dwordx4 v9, s[16:19], s56 offen offset:1024 nt lds
    buffer_load_dwordx4 v10, s[16:19], s56 offen offset:2048 nt lds
    buffer_load_dwordx4 v11, s[16:19], s56 offen offset:3072 nt lds
    s_mov_b32 m0, 106496
    s_mov_b32 s56, 114688
    buffer_load_dwordx4 v12, s[20:23], s56 offen offset:0 nt lds
    buffer_load_dwordx4 v12, s[20:23], s56 offen offset:1024 nt lds
    buffer_load_dwordx4 v12, s[20:23], s56 offen offset:2048 nt lds
    buffer_load_dwordx4 v12, s[20:23], s56 offen offset:3072 nt lds
    s_mov_b32 m0, 110592
    s_mov_b32 s56, 118784
    buffer_load_dwordx4 v12, s[20:23], s56 offen offset:0 nt lds
    buffer_load_dwordx4 v12, s[20:23], s56 offen offset:1024 nt lds
    buffer_load_dwordx4 v12, s[20:23], s56 offen offset:2048 nt lds
    buffer_load_dwordx4 v12, s[20:23], s56 offen offset:3072 nt lds
    s_waitcnt vmcnt(32)
    ds_read_b64_tr_b16 v[32:33], v21 offset:0
    ds_read_b64_tr_b16 v[34:35], v21 offset:1024
    ds_read_b64_tr_b16 v[36:37], v21 offset:2048
    ds_read_b64_tr_b16 v[38:39], v21 offset:3072
    ds_read_b64_tr_b16 v[40:41], v21 offset:4096
    ds_read_b64_tr_b16 v[42:43], v21 offset:5120
    ds_read_b64_tr_b16 v[44:45], v21 offset:6144
    ds_read_b64_tr_b16 v[46:47], v21 offset:7168
    ds_read_b64_tr_b16 v[48:49], v21 offset:8192
    ds_read_b64_tr_b16 v[50:51], v21 offset:9216
    ds_read_b64_tr_b16 v[52:53], v21 offset:10240
    ds_read_b64_tr_b16 v[54:55], v21 offset:11264
    ds_read_b64_tr_b16 v[56:57], v21 offset:12288
    ds_read_b64_tr_b16 v[58:59], v21 offset:13312
    ds_read_b64_tr_b16 v[60:61], v21 offset:14336
    ds_read_b64_tr_b16 v[62:63], v21 offset:15360
    ds_read_b64_tr_b16 v[64:65], v21 offset:64
    ds_read_b64_tr_b16 v[66:67], v21 offset:1088
    ds_read_b64_tr_b16 v[68:69], v21 offset:2112
    ds_read_b64_tr_b16 v[70:71], v21 offset:3136
    ds_read_b64_tr_b16 v[72:73], v21 offset:4160
    ds_read_b64_tr_b16 v[74:75], v21 offset:5184
    ds_read_b64_tr_b16 v[76:77], v21 offset:6208
    ds_read_b64_tr_b16 v[78:79], v21 offset:7232
    ds_read_b64_tr_b16 v[80:81], v21 offset:8256
    ds_read_b64_tr_b16 v[82:83], v21 offset:9280
    ds_read_b64_tr_b16 v[84:85], v21 offset:10304
    ds_read_b64_tr_b16 v[86:87], v21 offset:11328
    ds_read_b64_tr_b16 v[88:89], v21 offset:12352
    ds_read_b64_tr_b16 v[90:91], v21 offset:13376
    ds_read_b64_tr_b16 v[92:93], v21 offset:14400
    ds_read_b64_tr_b16 v[94:95], v21 offset:15424
    s_waitcnt lgkmcnt(0)
    v_lshlrev_b32 v19, 4, v2
    s_mov_b32 s56, 0
    buffer_store_dwordx4 v[32:35], v19, s[40:43], s56 offen offset:0 sc1
    s_mov_b32 s56, 0
    buffer_store_dwordx4 v[36:39], v19, s[40:43], s56 offen offset:1024 sc1
    s_mov_b32 s56, 0
    buffer_store_dwordx4 v[40:43], v19, s[40:43], s56 offen offset:2048 sc1
    s_mov_b32 s56, 0
    buffer_store_dwordx4 v[44:47], v19, s[40:43], s56 offen offset:3072 sc1
    s_mov_b32 s56, 4096
    buffer_store_dwordx4 v[48:51], v19, s[40:43], s56 offen offset:0 sc1
    s_mov_b32 s56, 4096
    buffer_store_dwordx4 v[52:55], v19, s[40:43], s56 offen offset:1024 sc1
    s_mov_b32 s56, 4096
    buffer_store_dwordx4 v[56:59], v19, s[40:43], s56 offen offset:2048 sc1
    s_mov_b32 s56, 4096
    buffer_store_dwordx4 v[60:63], v19, s[40:43], s56 offen offset:3072 sc1
    s_mov_b32 s56, 262144
    buffer_store_dwordx4 v[64:67], v19, s[40:43], s56 offen offset:0 sc1
    s_mov_b32 s56, 262144
    buffer_store_dwordx4 v[68:71], v19, s[40:43], s56 offen offset:1024 sc1
    s_mov_b32 s56, 262144
    buffer_store_dwordx4 v[72:75], v19, s[40:43], s56 offen offset:2048 sc1
    s_mov_b32 s56, 262144
    buffer_store_dwordx4 v[76:79], v19, s[40:43], s56 offen offset:3072 sc1
    s_mov_b32 s56, 266240
    buffer_store_dwordx4 v[80:83], v19, s[40:43], s56 offen offset:0 sc1
    s_mov_b32 s56, 266240
    buffer_store_dwordx4 v[84:87], v19, s[40:43], s56 offen offset:1024 sc1
    s_mov_b32 s56, 266240
    buffer_store_dwordx4 v[88:91], v19, s[40:43], s56 offen offset:2048 sc1
    s_mov_b32 s56, 266240
    buffer_store_dwordx4 v[92:95], v19, s[40:43], s56 offen offset:3072 sc1
L_pw_129:
    ds_read_b32 v16, v15
    s_waitcnt lgkmcnt(0)
    v_cmp_gt_u32 vcc, 24, v16
    s_cbranch_vccz L_pok_130
    s_sleep 2
    s_branch L_pw_129
L_pok_130:
    s_mov_b32 m0, 114688
    s_mov_b32 s56, 122880
    buffer_load_dwordx4 v8, s[16:19], s56 offen offset:0 nt lds
    buffer_load_dwordx4 v9, s[16:19], s56 offen offset:1024 nt lds
    buffer_load_dwordx4 v10, s[16:19], s56 offen offset:2048 nt lds
    buffer_load_dwordx4 v11, s[16:19], s56 offen offset:3072 nt lds
    s_mov_b32 m0, 118784
    s_mov_b32 s56, 126976
    buffer_load_dwordx4 v8, s[16:19], s56 offen offset:0 nt lds
    buffer_load_dwordx4 v9, s[16:19], s56 offen offset:1024 nt lds
    buffer_load_dwordx4 v10, s[16:19], s56 offen offset:2048 nt lds
    buffer_load_dwordx4 v11, s[16:19], s56 offen offset:3072 nt lds
    s_mov_b32 m0, 122880
    s_mov_b32 s56, 122880
    buffer_load_dwordx4 v12, s[20:23], s56 offen offset:0 nt lds
    buffer_load_dwordx4 v12, s[20:23], s56 offen offset:1024 nt lds
    buffer_load_dwordx4 v12, s[20:23], s56 offen offset:2048 nt lds
    buffer_load_dwordx4 v12, s[20:23], s56 offen offset:3072 nt lds
    s_mov_b32 m0, 126976
    s_mov_b32 s56, 126976
    buffer_load_dwordx4 v12, s[20:23], s56 offen offset:0 nt lds
    buffer_load_dwordx4 v12, s[20:23], s56 offen offset:1024 nt lds
    buffer_load_dwordx4 v12, s[20:23], s56 offen offset:2048 nt lds
    buffer_load_dwordx4 v12, s[20:23], s56 offen offset:3072 nt lds
    s_waitcnt vmcnt(32)
    s_mov_b64 exec, 1
    v_mov_b32 v18, 15
    ds_write_b32 v20, v18 offset:4
    s_mov_b64 exec, -1
L_pw_131:
    ds_read_b32 v16, v15
    s_waitcnt lgkmcnt(0)
    v_cmp_gt_u32 vcc, 25, v16
    s_cbranch_vccz L_pok_132
    s_sleep 2
    s_branch L_pw_131
L_pok_132:
    s_mov_b32 m0, 0
    s_mov_b32 s56, 131072
    buffer_load_dwordx4 v8, s[16:19], s56 offen offset:0 nt lds
    buffer_load_dwordx4 v9, s[16:19], s56 offen offset:1024 nt lds
    buffer_load_dwordx4 v10, s[16:19], s56 offen offset:2048 nt lds
    buffer_load_dwordx4 v11, s[16:19], s56 offen offset:3072 nt lds
    s_mov_b32 m0, 4096
    s_mov_b32 s56, 135168
    buffer_load_dwordx4 v8, s[16:19], s56 offen offset:0 nt lds
    buffer_load_dwordx4 v9, s[16:19], s56 offen offset:1024 nt lds
    buffer_load_dwordx4 v10, s[16:19], s56 offen offset:2048 nt lds
    buffer_load_dwordx4 v11, s[16:19], s56 offen offset:3072 nt lds
    s_mov_b32 m0, 8192
    s_mov_b32 s56, 131072
    buffer_load_dwordx4 v12, s[20:23], s56 offen offset:0 nt lds
    buffer_load_dwordx4 v12, s[20:23], s56 offen offset:1024 nt lds
    buffer_load_dwordx4 v12, s[20:23], s56 offen offset:2048 nt lds
    buffer_load_dwordx4 v12, s[20:23], s56 offen offset:3072 nt lds
    s_mov_b32 m0, 12288
    s_mov_b32 s56, 135168
    buffer_load_dwordx4 v12, s[20:23], s56 offen offset:0 nt lds
    buffer_load_dwordx4 v12, s[20:23], s56 offen offset:1024 nt lds
    buffer_load_dwordx4 v12, s[20:23], s56 offen offset:2048 nt lds
    buffer_load_dwordx4 v12, s[20:23], s56 offen offset:3072 nt lds
    s_waitcnt vmcnt(32)
L_pw_133:
    ds_read_b32 v16, v15
    s_waitcnt lgkmcnt(0)
    v_cmp_gt_u32 vcc, 26, v16
    s_cbranch_vccz L_pok_134
    s_sleep 2
    s_branch L_pw_133
L_pok_134:
    s_mov_b32 m0, 16384
    s_mov_b32 s56, 139264
    buffer_load_dwordx4 v8, s[16:19], s56 offen offset:0 nt lds
    buffer_load_dwordx4 v9, s[16:19], s56 offen offset:1024 nt lds
    buffer_load_dwordx4 v10, s[16:19], s56 offen offset:2048 nt lds
    buffer_load_dwordx4 v11, s[16:19], s56 offen offset:3072 nt lds
    s_mov_b32 m0, 20480
    s_mov_b32 s56, 143360
    buffer_load_dwordx4 v8, s[16:19], s56 offen offset:0 nt lds
    buffer_load_dwordx4 v9, s[16:19], s56 offen offset:1024 nt lds
    buffer_load_dwordx4 v10, s[16:19], s56 offen offset:2048 nt lds
    buffer_load_dwordx4 v11, s[16:19], s56 offen offset:3072 nt lds
    s_mov_b32 m0, 24576
    s_mov_b32 s56, 139264
    buffer_load_dwordx4 v12, s[20:23], s56 offen offset:0 nt lds
    buffer_load_dwordx4 v12, s[20:23], s56 offen offset:1024 nt lds
    buffer_load_dwordx4 v12, s[20:23], s56 offen offset:2048 nt lds
    buffer_load_dwordx4 v12, s[20:23], s56 offen offset:3072 nt lds
    s_mov_b32 m0, 28672
    s_mov_b32 s56, 143360
    buffer_load_dwordx4 v12, s[20:23], s56 offen offset:0 nt lds
    buffer_load_dwordx4 v12, s[20:23], s56 offen offset:1024 nt lds
    buffer_load_dwordx4 v12, s[20:23], s56 offen offset:2048 nt lds
    buffer_load_dwordx4 v12, s[20:23], s56 offen offset:3072 nt lds
    s_waitcnt vmcnt(32)
    s_mov_b64 exec, 1
    v_mov_b32 v18, 16
    ds_write_b32 v20, v18 offset:4
    s_mov_b64 exec, -1
L_pw_135:
    ds_read_b32 v16, v15
    s_waitcnt lgkmcnt(0)
    v_cmp_gt_u32 vcc, 27, v16
    s_cbranch_vccz L_pok_136
    s_sleep 2
    s_branch L_pw_135
L_pok_136:
    s_mov_b32 m0, 32768
    s_mov_b32 s56, 147456
    buffer_load_dwordx4 v8, s[16:19], s56 offen offset:0 nt lds
    buffer_load_dwordx4 v9, s[16:19], s56 offen offset:1024 nt lds
    buffer_load_dwordx4 v10, s[16:19], s56 offen offset:2048 nt lds
    buffer_load_dwordx4 v11, s[16:19], s56 offen offset:3072 nt lds
    s_mov_b32 m0, 36864
    s_mov_b32 s56, 151552
    buffer_load_dwordx4 v8, s[16:19], s56 offen offset:0 nt lds
    buffer_load_dwordx4 v9, s[16:19], s56 offen offset:1024 nt lds
    buffer_load_dwordx4 v10, s[16:19], s56 offen offset:2048 nt lds
    buffer_load_dwordx4 v11, s[16:19], s56 offen offset:3072 nt lds
    s_mov_b32 m0, 40960
    s_mov_b32 s56, 147456
    buffer_load_dwordx4 v12, s[20:23], s56 offen offset:0 nt lds
    buffer_load_dwordx4 v12, s[20:23], s56 offen offset:1024 nt lds
    buffer_load_dwordx4 v12, s[20:23], s56 offen offset:2048 nt lds
    buffer_load_dwordx4 v12, s[20:23], s56 offen offset:3072 nt lds
    s_mov_b32 m0, 45056
    s_mov_b32 s56, 151552
    buffer_load_dwordx4 v12, s[20:23], s56 offen offset:0 nt lds
    buffer_load_dwordx4 v12, s[20:23], s56 offen offset:1024 nt lds
    buffer_load_dwordx4 v12, s[20:23], s56 offen offset:2048 nt lds
    buffer_load_dwordx4 v12, s[20:23], s56 offen offset:3072 nt lds
    s_waitcnt vmcnt(32)
    s_mov_b64 exec, 1
    v_mov_b32 v18, 17
    ds_write_b32 v20, v18 offset:4
    s_mov_b64 exec, -1
L_pw_137:
    ds_read_b32 v16, v15
    s_waitcnt lgkmcnt(0)
    v_cmp_gt_u32 vcc, 28, v16
    s_cbranch_vccz L_pok_138
    s_sleep 2
    s_branch L_pw_137
L_pok_138:
    s_mov_b32 m0, 49152
    s_mov_b32 s56, 155648
    buffer_load_dwordx4 v8, s[16:19], s56 offen offset:0 nt lds
    buffer_load_dwordx4 v9, s[16:19], s56 offen offset:1024 nt lds
    buffer_load_dwordx4 v10, s[16:19], s56 offen offset:2048 nt lds
    buffer_load_dwordx4 v11, s[16:19], s56 offen offset:3072 nt lds
    s_mov_b32 m0, 53248
    s_mov_b32 s56, 159744
    buffer_load_dwordx4 v8, s[16:19], s56 offen offset:0 nt lds
    buffer_load_dwordx4 v9, s[16:19], s56 offen offset:1024 nt lds
    buffer_load_dwordx4 v10, s[16:19], s56 offen offset:2048 nt lds
    buffer_load_dwordx4 v11, s[16:19], s56 offen offset:3072 nt lds
    s_mov_b32 m0, 57344
    s_mov_b32 s56, 155648
    buffer_load_dwordx4 v12, s[20:23], s56 offen offset:0 nt lds
    buffer_load_dwordx4 v12, s[20:23], s56 offen offset:1024 nt lds
    buffer_load_dwordx4 v12, s[20:23], s56 offen offset:2048 nt lds
    buffer_load_dwordx4 v12, s[20:23], s56 offen offset:3072 nt lds
    s_mov_b32 m0, 61440
    s_mov_b32 s56, 159744
    buffer_load_dwordx4 v12, s[20:23], s56 offen offset:0 nt lds
    buffer_load_dwordx4 v12, s[20:23], s56 offen offset:1024 nt lds
    buffer_load_dwordx4 v12, s[20:23], s56 offen offset:2048 nt lds
    buffer_load_dwordx4 v12, s[20:23], s56 offen offset:3072 nt lds
    s_waitcnt vmcnt(32)
    s_mov_b64 exec, 1
    v_mov_b32 v18, 18
    ds_write_b32 v20, v18 offset:4
    s_mov_b64 exec, -1
L_pw_139:
    ds_read_b32 v16, v15
    s_waitcnt lgkmcnt(0)
    v_cmp_gt_u32 vcc, 29, v16
    s_cbranch_vccz L_pok_140
    s_sleep 2
    s_branch L_pw_139
L_pok_140:
    s_mov_b32 m0, 65536
    s_mov_b32 s56, 163840
    buffer_load_dwordx4 v8, s[16:19], s56 offen offset:0 nt lds
    buffer_load_dwordx4 v9, s[16:19], s56 offen offset:1024 nt lds
    buffer_load_dwordx4 v10, s[16:19], s56 offen offset:2048 nt lds
    buffer_load_dwordx4 v11, s[16:19], s56 offen offset:3072 nt lds
    s_mov_b32 m0, 69632
    s_mov_b32 s56, 167936
    buffer_load_dwordx4 v8, s[16:19], s56 offen offset:0 nt lds
    buffer_load_dwordx4 v9, s[16:19], s56 offen offset:1024 nt lds
    buffer_load_dwordx4 v10, s[16:19], s56 offen offset:2048 nt lds
    buffer_load_dwordx4 v11, s[16:19], s56 offen offset:3072 nt lds
    s_mov_b32 m0, 73728
    s_mov_b32 s56, 163840
    buffer_load_dwordx4 v12, s[20:23], s56 offen offset:0 nt lds
    buffer_load_dwordx4 v12, s[20:23], s56 offen offset:1024 nt lds
    buffer_load_dwordx4 v12, s[20:23], s56 offen offset:2048 nt lds
    buffer_load_dwordx4 v12, s[20:23], s56 offen offset:3072 nt lds
    s_mov_b32 m0, 77824
    s_mov_b32 s56, 167936
    buffer_load_dwordx4 v12, s[20:23], s56 offen offset:0 nt lds
    buffer_load_dwordx4 v12, s[20:23], s56 offen offset:1024 nt lds
    buffer_load_dwordx4 v12, s[20:23], s56 offen offset:2048 nt lds
    buffer_load_dwordx4 v12, s[20:23], s56 offen offset:3072 nt lds
    s_waitcnt vmcnt(32)
    s_mov_b64 exec, 1
    v_mov_b32 v18, 19
    ds_write_b32 v20, v18 offset:4
    s_mov_b64 exec, -1
L_pw_141:
    ds_read_b32 v16, v15
    s_waitcnt lgkmcnt(0)
    v_cmp_gt_u32 vcc, 30, v16
    s_cbranch_vccz L_pok_142
    s_sleep 2
    s_branch L_pw_141
L_pok_142:
    s_mov_b32 m0, 81920
    s_mov_b32 s56, 172032
    buffer_load_dwordx4 v8, s[16:19], s56 offen offset:0 nt lds
    buffer_load_dwordx4 v9, s[16:19], s56 offen offset:1024 nt lds
    buffer_load_dwordx4 v10, s[16:19], s56 offen offset:2048 nt lds
    buffer_load_dwordx4 v11, s[16:19], s56 offen offset:3072 nt lds
    s_mov_b32 m0, 86016
    s_mov_b32 s56, 176128
    buffer_load_dwordx4 v8, s[16:19], s56 offen offset:0 nt lds
    buffer_load_dwordx4 v9, s[16:19], s56 offen offset:1024 nt lds
    buffer_load_dwordx4 v10, s[16:19], s56 offen offset:2048 nt lds
    buffer_load_dwordx4 v11, s[16:19], s56 offen offset:3072 nt lds
    s_mov_b32 m0, 90112
    s_mov_b32 s56, 172032
    buffer_load_dwordx4 v12, s[20:23], s56 offen offset:0 nt lds
    buffer_load_dwordx4 v12, s[20:23], s56 offen offset:1024 nt lds
    buffer_load_dwordx4 v12, s[20:23], s56 offen offset:2048 nt lds
    buffer_load_dwordx4 v12, s[20:23], s56 offen offset:3072 nt lds
    s_mov_b32 m0, 94208
    s_mov_b32 s56, 176128
    buffer_load_dwordx4 v12, s[20:23], s56 offen offset:0 nt lds
    buffer_load_dwordx4 v12, s[20:23], s56 offen offset:1024 nt lds
    buffer_load_dwordx4 v12, s[20:23], s56 offen offset:2048 nt lds
    buffer_load_dwordx4 v12, s[20:23], s56 offen offset:3072 nt lds
    s_waitcnt vmcnt(32)
    s_mov_b64 exec, 1
    v_mov_b32 v18, 20
    ds_write_b32 v20, v18 offset:4
    s_mov_b64 exec, -1
L_pw_143:
    ds_read_b32 v16, v15
    s_waitcnt lgkmcnt(0)
    v_cmp_gt_u32 vcc, 31, v16
    s_cbranch_vccz L_pok_144
    s_sleep 2
    s_branch L_pw_143
L_pok_144:
    s_mov_b32 m0, 98304
    s_mov_b32 s56, 180224
    buffer_load_dwordx4 v8, s[16:19], s56 offen offset:0 nt lds
    buffer_load_dwordx4 v9, s[16:19], s56 offen offset:1024 nt lds
    buffer_load_dwordx4 v10, s[16:19], s56 offen offset:2048 nt lds
    buffer_load_dwordx4 v11, s[16:19], s56 offen offset:3072 nt lds
    s_mov_b32 m0, 102400
    s_mov_b32 s56, 184320
    buffer_load_dwordx4 v8, s[16:19], s56 offen offset:0 nt lds
    buffer_load_dwordx4 v9, s[16:19], s56 offen offset:1024 nt lds
    buffer_load_dwordx4 v10, s[16:19], s56 offen offset:2048 nt lds
    buffer_load_dwordx4 v11, s[16:19], s56 offen offset:3072 nt lds
    s_mov_b32 m0, 106496
    s_mov_b32 s56, 180224
    buffer_load_dwordx4 v12, s[20:23], s56 offen offset:0 nt lds
    buffer_load_dwordx4 v12, s[20:23], s56 offen offset:1024 nt lds
    buffer_load_dwordx4 v12, s[20:23], s56 offen offset:2048 nt lds
    buffer_load_dwordx4 v12, s[20:23], s56 offen offset:3072 nt lds
    s_mov_b32 m0, 110592
    s_mov_b32 s56, 184320
    buffer_load_dwordx4 v12, s[20:23], s56 offen offset:0 nt lds
    buffer_load_dwordx4 v12, s[20:23], s56 offen offset:1024 nt lds
    buffer_load_dwordx4 v12, s[20:23], s56 offen offset:2048 nt lds
    buffer_load_dwordx4 v12, s[20:23], s56 offen offset:3072 nt lds
    s_waitcnt vmcnt(32)
    s_mov_b64 exec, 1
    v_mov_b32 v18, 21
    ds_write_b32 v20, v18 offset:4
    s_mov_b64 exec, -1
L_pw_145:
    ds_read_b32 v16, v15
    s_waitcnt lgkmcnt(0)
    v_cmp_gt_u32 vcc, 32, v16
    s_cbranch_vccz L_pok_146
    s_sleep 2
    s_branch L_pw_145
L_pok_146:
    s_mov_b32 m0, 114688
    s_mov_b32 s56, 188416
    buffer_load_dwordx4 v8, s[16:19], s56 offen offset:0 nt lds
    buffer_load_dwordx4 v9, s[16:19], s56 offen offset:1024 nt lds
    buffer_load_dwordx4 v10, s[16:19], s56 offen offset:2048 nt lds
    buffer_load_dwordx4 v11, s[16:19], s56 offen offset:3072 nt lds
    s_mov_b32 m0, 118784
    s_mov_b32 s56, 192512
    buffer_load_dwordx4 v8, s[16:19], s56 offen offset:0 nt lds
    buffer_load_dwordx4 v9, s[16:19], s56 offen offset:1024 nt lds
    buffer_load_dwordx4 v10, s[16:19], s56 offen offset:2048 nt lds
    buffer_load_dwordx4 v11, s[16:19], s56 offen offset:3072 nt lds
    s_mov_b32 m0, 122880
    s_mov_b32 s56, 188416
    buffer_load_dwordx4 v12, s[20:23], s56 offen offset:0 nt lds
    buffer_load_dwordx4 v12, s[20:23], s56 offen offset:1024 nt lds
    buffer_load_dwordx4 v12, s[20:23], s56 offen offset:2048 nt lds
    buffer_load_dwordx4 v12, s[20:23], s56 offen offset:3072 nt lds
    s_mov_b32 m0, 126976
    s_mov_b32 s56, 192512
    buffer_load_dwordx4 v12, s[20:23], s56 offen offset:0 nt lds
    buffer_load_dwordx4 v12, s[20:23], s56 offen offset:1024 nt lds
    buffer_load_dwordx4 v12, s[20:23], s56 offen offset:2048 nt lds
    buffer_load_dwordx4 v12, s[20:23], s56 offen offset:3072 nt lds
    s_waitcnt vmcnt(32)
    s_mov_b64 exec, 1
    v_mov_b32 v18, 22
    ds_write_b32 v20, v18 offset:4
    s_mov_b64 exec, -1
L_pw_147:
    ds_read_b32 v16, v15
    s_waitcnt lgkmcnt(0)
    v_cmp_gt_u32 vcc, 33, v16
    s_cbranch_vccz L_pok_148
    s_sleep 2
    s_branch L_pw_147
L_pok_148:
    s_mov_b32 m0, 0
    s_mov_b32 s56, 196608
    buffer_load_dwordx4 v8, s[16:19], s56 offen offset:0 nt lds
    buffer_load_dwordx4 v9, s[16:19], s56 offen offset:1024 nt lds
    buffer_load_dwordx4 v10, s[16:19], s56 offen offset:2048 nt lds
    buffer_load_dwordx4 v11, s[16:19], s56 offen offset:3072 nt lds
    s_mov_b32 m0, 4096
    s_mov_b32 s56, 200704
    buffer_load_dwordx4 v8, s[16:19], s56 offen offset:0 nt lds
    buffer_load_dwordx4 v9, s[16:19], s56 offen offset:1024 nt lds
    buffer_load_dwordx4 v10, s[16:19], s56 offen offset:2048 nt lds
    buffer_load_dwordx4 v11, s[16:19], s56 offen offset:3072 nt lds
    s_mov_b32 m0, 8192
    s_mov_b32 s56, 196608
    buffer_load_dwordx4 v12, s[20:23], s56 offen offset:0 nt lds
    buffer_load_dwordx4 v12, s[20:23], s56 offen offset:1024 nt lds
    buffer_load_dwordx4 v12, s[20:23], s56 offen offset:2048 nt lds
    buffer_load_dwordx4 v12, s[20:23], s56 offen offset:3072 nt lds
    s_mov_b32 m0, 12288
    s_mov_b32 s56, 200704
    buffer_load_dwordx4 v12, s[20:23], s56 offen offset:0 nt lds
    buffer_load_dwordx4 v12, s[20:23], s56 offen offset:1024 nt lds
    buffer_load_dwordx4 v12, s[20:23], s56 offen offset:2048 nt lds
    buffer_load_dwordx4 v12, s[20:23], s56 offen offset:3072 nt lds
    s_waitcnt vmcnt(32)
    s_mov_b64 exec, 1
    v_mov_b32 v18, 23
    ds_write_b32 v20, v18 offset:4
    s_mov_b64 exec, -1
L_pw_149:
    ds_read_b32 v16, v15
    s_waitcnt lgkmcnt(0)
    v_cmp_gt_u32 vcc, 34, v16
    s_cbranch_vccz L_pok_150
    s_sleep 2
    s_branch L_pw_149
L_pok_150:
    s_mov_b32 m0, 16384
    s_mov_b32 s56, 204800
    buffer_load_dwordx4 v8, s[16:19], s56 offen offset:0 nt lds
    buffer_load_dwordx4 v9, s[16:19], s56 offen offset:1024 nt lds
    buffer_load_dwordx4 v10, s[16:19], s56 offen offset:2048 nt lds
    buffer_load_dwordx4 v11, s[16:19], s56 offen offset:3072 nt lds
    s_mov_b32 m0, 20480
    s_mov_b32 s56, 208896
    buffer_load_dwordx4 v8, s[16:19], s56 offen offset:0 nt lds
    buffer_load_dwordx4 v9, s[16:19], s56 offen offset:1024 nt lds
    buffer_load_dwordx4 v10, s[16:19], s56 offen offset:2048 nt lds
    buffer_load_dwordx4 v11, s[16:19], s56 offen offset:3072 nt lds
    s_mov_b32 m0, 24576
    s_mov_b32 s56, 204800
    buffer_load_dwordx4 v12, s[20:23], s56 offen offset:0 nt lds
    buffer_load_dwordx4 v12, s[20:23], s56 offen offset:1024 nt lds
    buffer_load_dwordx4 v12, s[20:23], s56 offen offset:2048 nt lds
    buffer_load_dwordx4 v12, s[20:23], s56 offen offset:3072 nt lds
    s_mov_b32 m0, 28672
    s_mov_b32 s56, 208896
    buffer_load_dwordx4 v12, s[20:23], s56 offen offset:0 nt lds
    buffer_load_dwordx4 v12, s[20:23], s56 offen offset:1024 nt lds
    buffer_load_dwordx4 v12, s[20:23], s56 offen offset:2048 nt lds
    buffer_load_dwordx4 v12, s[20:23], s56 offen offset:3072 nt lds
    s_waitcnt vmcnt(32)
    s_mov_b64 exec, 1
    v_mov_b32 v18, 24
    ds_write_b32 v20, v18 offset:4
    s_mov_b64 exec, -1
L_pw_151:
    ds_read_b32 v16, v15
    s_waitcnt lgkmcnt(0)
    v_cmp_gt_u32 vcc, 35, v16
    s_cbranch_vccz L_pok_152
    s_sleep 2
    s_branch L_pw_151
L_pok_152:
    s_mov_b32 m0, 32768
    s_mov_b32 s56, 212992
    buffer_load_dwordx4 v8, s[16:19], s56 offen offset:0 nt lds
    buffer_load_dwordx4 v9, s[16:19], s56 offen offset:1024 nt lds
    buffer_load_dwordx4 v10, s[16:19], s56 offen offset:2048 nt lds
    buffer_load_dwordx4 v11, s[16:19], s56 offen offset:3072 nt lds
    s_mov_b32 m0, 36864
    s_mov_b32 s56, 217088
    buffer_load_dwordx4 v8, s[16:19], s56 offen offset:0 nt lds
    buffer_load_dwordx4 v9, s[16:19], s56 offen offset:1024 nt lds
    buffer_load_dwordx4 v10, s[16:19], s56 offen offset:2048 nt lds
    buffer_load_dwordx4 v11, s[16:19], s56 offen offset:3072 nt lds
    s_mov_b32 m0, 40960
    s_mov_b32 s56, 212992
    buffer_load_dwordx4 v12, s[20:23], s56 offen offset:0 nt lds
    buffer_load_dwordx4 v12, s[20:23], s56 offen offset:1024 nt lds
    buffer_load_dwordx4 v12, s[20:23], s56 offen offset:2048 nt lds
    buffer_load_dwordx4 v12, s[20:23], s56 offen offset:3072 nt lds
    s_mov_b32 m0, 45056
    s_mov_b32 s56, 217088
    buffer_load_dwordx4 v12, s[20:23], s56 offen offset:0 nt lds
    buffer_load_dwordx4 v12, s[20:23], s56 offen offset:1024 nt lds
    buffer_load_dwordx4 v12, s[20:23], s56 offen offset:2048 nt lds
    buffer_load_dwordx4 v12, s[20:23], s56 offen offset:3072 nt lds
    s_waitcnt vmcnt(32)
    s_mov_b64 exec, 1
    v_mov_b32 v18, 25
    ds_write_b32 v20, v18 offset:4
    s_mov_b64 exec, -1
L_pw_153:
    ds_read_b32 v16, v15
    s_waitcnt lgkmcnt(0)
    v_cmp_gt_u32 vcc, 36, v16
    s_cbranch_vccz L_pok_154
    s_sleep 2
    s_branch L_pw_153
L_pok_154:
    s_mov_b32 m0, 49152
    s_mov_b32 s56, 221184
    buffer_load_dwordx4 v8, s[16:19], s56 offen offset:0 nt lds
    buffer_load_dwordx4 v9, s[16:19], s56 offen offset:1024 nt lds
    buffer_load_dwordx4 v10, s[16:19], s56 offen offset:2048 nt lds
    buffer_load_dwordx4 v11, s[16:19], s56 offen offset:3072 nt lds
    s_mov_b32 m0, 53248
    s_mov_b32 s56, 225280
    buffer_load_dwordx4 v8, s[16:19], s56 offen offset:0 nt lds
    buffer_load_dwordx4 v9, s[16:19], s56 offen offset:1024 nt lds
    buffer_load_dwordx4 v10, s[16:19], s56 offen offset:2048 nt lds
    buffer_load_dwordx4 v11, s[16:19], s56 offen offset:3072 nt lds
    s_mov_b32 m0, 57344
    s_mov_b32 s56, 221184
    buffer_load_dwordx4 v12, s[20:23], s56 offen offset:0 nt lds
    buffer_load_dwordx4 v12, s[20:23], s56 offen offset:1024 nt lds
    buffer_load_dwordx4 v12, s[20:23], s56 offen offset:2048 nt lds
    buffer_load_dwordx4 v12, s[20:23], s56 offen offset:3072 nt lds
    s_mov_b32 m0, 61440
    s_mov_b32 s56, 225280
    buffer_load_dwordx4 v12, s[20:23], s56 offen offset:0 nt lds
    buffer_load_dwordx4 v12, s[20:23], s56 offen offset:1024 nt lds
    buffer_load_dwordx4 v12, s[20:23], s56 offen offset:2048 nt lds
    buffer_load_dwordx4 v12, s[20:23], s56 offen offset:3072 nt lds
    s_waitcnt vmcnt(32)
    s_mov_b64 exec, 1
    v_mov_b32 v18, 26
    ds_write_b32 v20, v18 offset:4
    s_mov_b64 exec, -1
L_pw_155:
    ds_read_b32 v16, v15
    s_waitcnt lgkmcnt(0)
    v_cmp_gt_u32 vcc, 37, v16
    s_cbranch_vccz L_pok_156
    s_sleep 2
    s_branch L_pw_155
L_pok_156:
    s_mov_b32 m0, 65536
    s_mov_b32 s56, 229376
    buffer_load_dwordx4 v8, s[16:19], s56 offen offset:0 nt lds
    buffer_load_dwordx4 v9, s[16:19], s56 offen offset:1024 nt lds
    buffer_load_dwordx4 v10, s[16:19], s56 offen offset:2048 nt lds
    buffer_load_dwordx4 v11, s[16:19], s56 offen offset:3072 nt lds
    s_mov_b32 m0, 69632
    s_mov_b32 s56, 233472
    buffer_load_dwordx4 v8, s[16:19], s56 offen offset:0 nt lds
    buffer_load_dwordx4 v9, s[16:19], s56 offen offset:1024 nt lds
    buffer_load_dwordx4 v10, s[16:19], s56 offen offset:2048 nt lds
    buffer_load_dwordx4 v11, s[16:19], s56 offen offset:3072 nt lds
    s_mov_b32 m0, 73728
    s_mov_b32 s56, 229376
    buffer_load_dwordx4 v12, s[20:23], s56 offen offset:0 nt lds
    buffer_load_dwordx4 v12, s[20:23], s56 offen offset:1024 nt lds
    buffer_load_dwordx4 v12, s[20:23], s56 offen offset:2048 nt lds
    buffer_load_dwordx4 v12, s[20:23], s56 offen offset:3072 nt lds
    s_mov_b32 m0, 77824
    s_mov_b32 s56, 233472
    buffer_load_dwordx4 v12, s[20:23], s56 offen offset:0 nt lds
    buffer_load_dwordx4 v12, s[20:23], s56 offen offset:1024 nt lds
    buffer_load_dwordx4 v12, s[20:23], s56 offen offset:2048 nt lds
    buffer_load_dwordx4 v12, s[20:23], s56 offen offset:3072 nt lds
    s_waitcnt vmcnt(32)
    s_mov_b64 exec, 1
    v_mov_b32 v18, 27
    ds_write_b32 v20, v18 offset:4
    s_mov_b64 exec, -1
L_pw_157:
    ds_read_b32 v16, v15
    s_waitcnt lgkmcnt(0)
    v_cmp_gt_u32 vcc, 38, v16
    s_cbranch_vccz L_pok_158
    s_sleep 2
    s_branch L_pw_157
L_pok_158:
    s_mov_b32 m0, 81920
    s_mov_b32 s56, 237568
    buffer_load_dwordx4 v8, s[16:19], s56 offen offset:0 nt lds
    buffer_load_dwordx4 v9, s[16:19], s56 offen offset:1024 nt lds
    buffer_load_dwordx4 v10, s[16:19], s56 offen offset:2048 nt lds
    buffer_load_dwordx4 v11, s[16:19], s56 offen offset:3072 nt lds
    s_mov_b32 m0, 86016
    s_mov_b32 s56, 241664
    buffer_load_dwordx4 v8, s[16:19], s56 offen offset:0 nt lds
    buffer_load_dwordx4 v9, s[16:19], s56 offen offset:1024 nt lds
    buffer_load_dwordx4 v10, s[16:19], s56 offen offset:2048 nt lds
    buffer_load_dwordx4 v11, s[16:19], s56 offen offset:3072 nt lds
    s_mov_b32 m0, 90112
    s_mov_b32 s56, 237568
    buffer_load_dwordx4 v12, s[20:23], s56 offen offset:0 nt lds
    buffer_load_dwordx4 v12, s[20:23], s56 offen offset:1024 nt lds
    buffer_load_dwordx4 v12, s[20:23], s56 offen offset:2048 nt lds
    buffer_load_dwordx4 v12, s[20:23], s56 offen offset:3072 nt lds
    s_mov_b32 m0, 94208
    s_mov_b32 s56, 241664
    buffer_load_dwordx4 v12, s[20:23], s56 offen offset:0 nt lds
    buffer_load_dwordx4 v12, s[20:23], s56 offen offset:1024 nt lds
    buffer_load_dwordx4 v12, s[20:23], s56 offen offset:2048 nt lds
    buffer_load_dwordx4 v12, s[20:23], s56 offen offset:3072 nt lds
    s_waitcnt vmcnt(32)
    s_mov_b64 exec, 1
    v_mov_b32 v18, 28
    ds_write_b32 v20, v18 offset:4
    s_mov_b64 exec, -1
L_pw_159:
    ds_read_b32 v16, v15
    s_waitcnt lgkmcnt(0)
    v_cmp_gt_u32 vcc, 39, v16
    s_cbranch_vccz L_pok_160
    s_sleep 2
    s_branch L_pw_159
L_pok_160:
    s_mov_b32 m0, 98304
    s_mov_b32 s56, 245760
    buffer_load_dwordx4 v8, s[16:19], s56 offen offset:0 nt lds
    buffer_load_dwordx4 v9, s[16:19], s56 offen offset:1024 nt lds
    buffer_load_dwordx4 v10, s[16:19], s56 offen offset:2048 nt lds
    buffer_load_dwordx4 v11, s[16:19], s56 offen offset:3072 nt lds
    s_mov_b32 m0, 102400
    s_mov_b32 s56, 249856
    buffer_load_dwordx4 v8, s[16:19], s56 offen offset:0 nt lds
    buffer_load_dwordx4 v9, s[16:19], s56 offen offset:1024 nt lds
    buffer_load_dwordx4 v10, s[16:19], s56 offen offset:2048 nt lds
    buffer_load_dwordx4 v11, s[16:19], s56 offen offset:3072 nt lds
    s_mov_b32 m0, 106496
    s_mov_b32 s56, 245760
    buffer_load_dwordx4 v12, s[20:23], s56 offen offset:0 nt lds
    buffer_load_dwordx4 v12, s[20:23], s56 offen offset:1024 nt lds
    buffer_load_dwordx4 v12, s[20:23], s56 offen offset:2048 nt lds
    buffer_load_dwordx4 v12, s[20:23], s56 offen offset:3072 nt lds
    s_mov_b32 m0, 110592
    s_mov_b32 s56, 249856
    buffer_load_dwordx4 v12, s[20:23], s56 offen offset:0 nt lds
    buffer_load_dwordx4 v12, s[20:23], s56 offen offset:1024 nt lds
    buffer_load_dwordx4 v12, s[20:23], s56 offen offset:2048 nt lds
    buffer_load_dwordx4 v12, s[20:23], s56 offen offset:3072 nt lds
    s_waitcnt vmcnt(32)
    s_mov_b64 exec, 1
    v_mov_b32 v18, 29
    ds_write_b32 v20, v18 offset:4
    s_mov_b64 exec, -1
L_pw_161:
    ds_read_b32 v16, v15
    s_waitcnt lgkmcnt(0)
    v_cmp_gt_u32 vcc, 40, v16
    s_cbranch_vccz L_pok_162
    s_sleep 2
    s_branch L_pw_161
L_pok_162:
    s_mov_b32 m0, 114688
    s_mov_b32 s56, 253952
    buffer_load_dwordx4 v8, s[16:19], s56 offen offset:0 nt lds
    buffer_load_dwordx4 v9, s[16:19], s56 offen offset:1024 nt lds
    buffer_load_dwordx4 v10, s[16:19], s56 offen offset:2048 nt lds
    buffer_load_dwordx4 v11, s[16:19], s56 offen offset:3072 nt lds
    s_mov_b32 m0, 118784
    s_mov_b32 s56, 258048
    buffer_load_dwordx4 v8, s[16:19], s56 offen offset:0 nt lds
    buffer_load_dwordx4 v9, s[16:19], s56 offen offset:1024 nt lds
    buffer_load_dwordx4 v10, s[16:19], s56 offen offset:2048 nt lds
    buffer_load_dwordx4 v11, s[16:19], s56 offen offset:3072 nt lds
    s_mov_b32 m0, 122880
    s_mov_b32 s56, 253952
    buffer_load_dwordx4 v12, s[20:23], s56 offen offset:0 nt lds
    buffer_load_dwordx4 v12, s[20:23], s56 offen offset:1024 nt lds
    buffer_load_dwordx4 v12, s[20:23], s56 offen offset:2048 nt lds
    buffer_load_dwordx4 v12, s[20:23], s56 offen offset:3072 nt lds
    s_mov_b32 m0, 126976
    s_mov_b32 s56, 258048
    buffer_load_dwordx4 v12, s[20:23], s56 offen offset:0 nt lds
    buffer_load_dwordx4 v12, s[20:23], s56 offen offset:1024 nt lds
    buffer_load_dwordx4 v12, s[20:23], s56 offen offset:2048 nt lds
    buffer_load_dwordx4 v12, s[20:23], s56 offen offset:3072 nt lds
    s_waitcnt vmcnt(32)
    s_mov_b64 exec, 1
    v_mov_b32 v18, 30
    ds_write_b32 v20, v18 offset:4
    s_mov_b64 exec, -1
    s_waitcnt vmcnt(16)
    s_mov_b64 exec, 1
    v_mov_b32 v18, 31
    ds_write_b32 v20, v18 offset:4
    s_mov_b64 exec, -1
    s_waitcnt vmcnt(0)
    s_mov_b64 exec, 1
    v_mov_b32 v18, 32
    ds_write_b32 v20, v18 offset:4
    s_mov_b64 exec, -1
    s_waitcnt vmcnt(0) lgkmcnt(0)
L1_done:
    s_endpgm
.globl standalone__mha_block_cached__near_ridge_kernel
.p2align 8
.type standalone__mha_block_cached__near_ridge_kernel,@function
standalone__mha_block_cached__near_ridge_kernel:
    s_cmp_ge_u32 s2, 224
    s_cbranch_scc1 L2_done
    s_load_dwordx2 s[4:5], s[0:1], 56
    s_load_dwordx2 s[6:7], s[0:1], 40
    v_lshrrev_b32 v1, 6, v0
    v_and_b32 v2, 63, v0
    v_readfirstlane_b32 s20, v1
    s_and_b32 s23, s2, 1
    s_lshl_b32 s23, s23, 2
    s_lshr_b32 s24, s2, 3
    s_and_b32 s22, s24, 3
    s_add_u32 s22, s22, s23
    s_lshr_b32 s24, s24, 2
    s_bfe_u32 s23, s2, 0x20001
    s_mul_i32 s23, s23, 7
    s_add_u32 s21, s23, s24
    s_waitcnt lgkmcnt(0)
    s_lshl_b32 s23, s21, 19
    s_add_u32 s8, s4, s23
    s_addc_u32 s9, s5, 0
    s_and_b32 s9, s9, 0xffff
    s_mov_b32 s10, 524288
    s_mov_b32 s11, 0x00020000
    s_lshl_b32 s23, s22, 19
    s_add_u32 s23, s23, 16777216
    s_add_u32 s12, s4, s23
    s_addc_u32 s13, s5, 0
    s_and_b32 s13, s13, 0xffff
    s_mov_b32 s14, 524288
    s_mov_b32 s15, 0x00020000
    s_lshl_b32 s23, s21, 16
    s_lshl_b32 s24, s22, 7
    s_add_u32 s23, s23, s24
    s_sub_u32 s24, 65536, s24
    s_add_u32 s16, s6, s23
    s_addc_u32 s17, s7, 0
    s_and_b32 s17, s17, 0xffff
    s_mov_b32 s18, s24
    s_mov_b32 s19, 0x00020000
    s_lshl_b32 s23, s20, 15
    v_lshlrev_b32 v3, 4, v2
    v_add_u32 v3, s23, v3
    v_add_u32 v4, 0x40000, v3
    s_mov_b32 s25, 0
    buffer_load_dwordx4 v[80:83], v3, s[12:15], s25 offen offset:0
    buffer_load_dwordx4 v[84:87], v4, s[12:15], s25 offen offset:0
    buffer_load_dwordx4 v[88:91], v3, s[8:11], s25 offen offset:0
    buffer_load_dwordx4 v[92:95], v4, s[8:11], s25 offen offset:0
    s_mov_b32 s25, 0
    buffer_load_dwordx4 v[96:99], v3, s[12:15], s25 offen offset:1024
    buffer_load_dwordx4 v[100:103], v4, s[12:15], s25 offen offset:1024
    buffer_load_dwordx4 v[104:107], v3, s[8:11], s25 offen offset:1024
    buffer_load_dwordx4 v[108:111], v4, s[8:11], s25 offen offset:1024
    s_mov_b32 s25, 0
    buffer_load_dwordx4 v[112:115], v3, s[12:15], s25 offen offset:2048
    buffer_load_dwordx4 v[116:119], v4, s[12:15], s25 offen offset:2048
    buffer_load_dwordx4 v[120:123], v3, s[8:11], s25 offen offset:2048
    buffer_load_dwordx4 v[124:127], v4, s[8:11], s25 offen offset:2048
    s_mov_b32 s25, 0
    buffer_load_dwordx4 v[128:131], v3, s[12:15], s25 offen offset:3072
    buffer_load_dwordx4 v[132:135], v4, s[12:15], s25 offen offset:3072
    buffer_load_dwordx4 v[136:139], v3, s[8:11], s25 offen offset:3072
    buffer_load_dwordx4 v[140:143], v4, s[8:11], s25 offen offset:3072
    s_mov_b32 s25, 4096
    buffer_load_dwordx4 v[144:147], v3, s[12:15], s25 offen offset:0
    buffer_load_dwordx4 v[148:151], v4, s[12:15], s25 offen offset:0
    buffer_load_dwordx4 v[152:155], v3, s[8:11], s25 offen offset:0
    buffer_load_dwordx4 v[156:159], v4, s[8:11], s25 offen offset:0
    s_mov_b32 s25, 4096
    buffer_load_dwordx4 v[160:163], v3, s[12:15], s25 offen offset:1024
    buffer_load_dwordx4 v[164:167], v4, s[12:15], s25 offen offset:1024
    buffer_load_dwordx4 v[168:171], v3, s[8:11], s25 offen offset:1024
    buffer_load_dwordx4 v[172:175], v4, s[8:11], s25 offen offset:1024
    s_mov_b32 s25, 4096
    buffer_load_dwordx4 v[176:179], v3, s[12:15], s25 offen offset:2048
    buffer_load_dwordx4 v[180:183], v4, s[12:15], s25 offen offset:2048
    buffer_load_dwordx4 v[184:187], v3, s[8:11], s25 offen offset:2048
    buffer_load_dwordx4 v[188:191], v4, s[8:11], s25 offen offset:2048
    s_mov_b32 s25, 4096
    buffer_load_dwordx4 v[192:195], v3, s[12:15], s25 offen offset:3072
    buffer_load_dwordx4 v[196:199], v4, s[12:15], s25 offen offset:3072
    buffer_load_dwordx4 v[200:203], v3, s[8:11], s25 offen offset:3072
    buffer_load_dwordx4 v[204:207], v4, s[8:11], s25 offen offset:3072
    v_mov_b32 v16, 0
    v_mov_b32 v17, 0
    v_mov_b32 v18, 0
    v_mov_b32 v19, 0
    v_mov_b32 v20, 0
    v_mov_b32 v21, 0
    v_mov_b32 v22, 0
    v_mov_b32 v23, 0
    v_mov_b32 v24, 0
    v_mov_b32 v25, 0
    v_mov_b32 v26, 0
    v_mov_b32 v27, 0
    v_mov_b32 v28, 0
    v_mov_b32 v29, 0
    v_mov_b32 v30, 0
    v_mov_b32 v31, 0
    v_mov_b32 v32, 0
    v_mov_b32 v33, 0
    v_mov_b32 v34, 0
    v_mov_b32 v35, 0
    v_mov_b32 v36, 0
    v_mov_b32 v37, 0
    v_mov_b32 v38, 0
    v_mov_b32 v39, 0
    v_mov_b32 v40, 0
    v_mov_b32 v41, 0
    v_mov_b32 v42, 0
    v_mov_b32 v43, 0
    v_mov_b32 v44, 0
    v_mov_b32 v45, 0
    v_mov_b32 v46, 0
    v_mov_b32 v47, 0
    v_mov_b32 v48, 0
    v_mov_b32 v49, 0
    v_mov_b32 v50, 0
    v_mov_b32 v51, 0
    v_mov_b32 v52, 0
    v_mov_b32 v53, 0
    v_mov_b32 v54, 0
    v_mov_b32 v55, 0
    v_mov_b32 v56, 0
    v_mov_b32 v57, 0
    v_mov_b32 v58, 0
    v_mov_b32 v59, 0
    v_mov_b32 v60, 0
    v_mov_b32 v61, 0
    v_mov_b32 v62, 0
    v_mov_b32 v63, 0
    v_mov_b32 v64, 0
    v_mov_b32 v65, 0
    v_mov_b32 v66, 0
    v_mov_b32 v67, 0
    v_mov_b32 v68, 0
    v_mov_b32 v69, 0
    v_mov_b32 v70, 0
    v_mov_b32 v71, 0
    v_mov_b32 v72, 0
    v_mov_b32 v73, 0
    v_mov_b32 v74, 0
    v_mov_b32 v75, 0
    v_mov_b32 v76, 0
    v_mov_b32 v77, 0
    v_mov_b32 v78, 0
    v_mov_b32 v79, 0
    s_waitcnt vmcnt(28)
    v_mfma_f32_32x32x16_bf16 v[16:31], v[80:83], v[88:91], v[16:31]
    v_mfma_f32_32x32x16_bf16 v[32:47], v[84:87], v[88:91], v[32:47]
    v_mfma_f32_32x32x16_bf16 v[48:63], v[80:83], v[92:95], v[48:63]
    v_mfma_f32_32x32x16_bf16 v[64:79], v[84:87], v[92:95], v[64:79]
    s_mov_b32 s25, 8192
    buffer_load_dwordx4 v[80:83], v3, s[12:15], s25 offen offset:0
    buffer_load_dwordx4 v[84:87], v4, s[12:15], s25 offen offset:0
    buffer_load_dwordx4 v[88:91], v3, s[8:11], s25 offen offset:0
    buffer_load_dwordx4 v[92:95], v4, s[8:11], s25 offen offset:0
    s_waitcnt vmcnt(28)
    v_mfma_f32_32x32x16_bf16 v[16:31], v[96:99], v[104:107], v[16:31]
    v_mfma_f32_32x32x16_bf16 v[32:47], v[100:103], v[104:107], v[32:47]
    v_mfma_f32_32x32x16_bf16 v[48:63], v[96:99], v[108:111], v[48:63]
    v_mfma_f32_32x32x16_bf16 v[64:79], v[100:103], v[108:111], v[64:79]
    s_mov_b32 s25, 8192
    buffer_load_dwordx4 v[96:99], v3, s[12:15], s25 offen offset:1024
    buffer_load_dwordx4 v[100:103], v4, s[12:15], s25 offen offset:1024
    buffer_load_dwordx4 v[104:107], v3, s[8:11], s25 offen offset:1024
    buffer_load_dwordx4 v[108:111], v4, s[8:11], s25 offen offset:1024
    s_waitcnt vmcnt(28)
    v_mfma_f32_32x32x16_bf16 v[16:31], v[112:115], v[120:123], v[16:31]
    v_mfma_f32_32x32x16_bf16 v[32:47], v[116:119], v[120:123], v[32:47]
    v_mfma_f32_32x32x16_bf16 v[48:63], v[112:115], v[124:127], v[48:63]
    v_mfma_f32_32x32x16_bf16 v[64:79], v[116:119], v[124:127], v[64:79]
    s_mov_b32 s25, 8192
    buffer_load_dwordx4 v[112:115], v3, s[12:15], s25 offen offset:2048
    buffer_load_dwordx4 v[116:119], v4, s[12:15], s25 offen offset:2048
    buffer_load_dwordx4 v[120:123], v3, s[8:11], s25 offen offset:2048
    buffer_load_dwordx4 v[124:127], v4, s[8:11], s25 offen offset:2048
    s_waitcnt vmcnt(28)
    v_mfma_f32_32x32x16_bf16 v[16:31], v[128:131], v[136:139], v[16:31]
    v_mfma_f32_32x32x16_bf16 v[32:47], v[132:135], v[136:139], v[32:47]
    v_mfma_f32_32x32x16_bf16 v[48:63], v[128:131], v[140:143], v[48:63]
    v_mfma_f32_32x32x16_bf16 v[64:79], v[132:135], v[140:143], v[64:79]
    s_mov_b32 s25, 8192
    buffer_load_dwordx4 v[128:131], v3, s[12:15], s25 offen offset:3072
    buffer_load_dwordx4 v[132:135], v4, s[12:15], s25 offen offset:3072
    buffer_load_dwordx4 v[136:139], v3, s[8:11], s25 offen offset:3072
    buffer_load_dwordx4 v[140:143], v4, s[8:11], s25 offen offset:3072
    s_waitcnt vmcnt(28)
    v_mfma_f32_32x32x16_bf16 v[16:31], v[144:147], v[152:155], v[16:31]
    v_mfma_f32_32x32x16_bf16 v[32:47], v[148:151], v[152:155], v[32:47]
    v_mfma_f32_32x32x16_bf16 v[48:63], v[144:147], v[156:159], v[48:63]
    v_mfma_f32_32x32x16_bf16 v[64:79], v[148:151], v[156:159], v[64:79]
    s_mov_b32 s25, 12288
    buffer_load_dwordx4 v[144:147], v3, s[12:15], s25 offen offset:0
    buffer_load_dwordx4 v[148:151], v4, s[12:15], s25 offen offset:0
    buffer_load_dwordx4 v[152:155], v3, s[8:11], s25 offen offset:0
    buffer_load_dwordx4 v[156:159], v4, s[8:11], s25 offen offset:0
    s_waitcnt vmcnt(28)
    v_mfma_f32_32x32x16_bf16 v[16:31], v[160:163], v[168:171], v[16:31]
    v_mfma_f32_32x32x16_bf16 v[32:47], v[164:167], v[168:171], v[32:47]
    v_mfma_f32_32x32x16_bf16 v[48:63], v[160:163], v[172:175], v[48:63]
    v_mfma_f32_32x32x16_bf16 v[64:79], v[164:167], v[172:175], v[64:79]
    s_mov_b32 s25, 12288
    buffer_load_dwordx4 v[160:163], v3, s[12:15], s25 offen offset:1024
    buffer_load_dwordx4 v[164:167], v4, s[12:15], s25 offen offset:1024
    buffer_load_dwordx4 v[168:171], v3, s[8:11], s25 offen offset:1024
    buffer_load_dwordx4 v[172:175], v4, s[8:11], s25 offen offset:1024
    s_waitcnt vmcnt(28)
    v_mfma_f32_32x32x16_bf16 v[16:31], v[176:179], v[184:187], v[16:31]
    v_mfma_f32_32x32x16_bf16 v[32:47], v[180:183], v[184:187], v[32:47]
    v_mfma_f32_32x32x16_bf16 v[48:63], v[176:179], v[188:191], v[48:63]
    v_mfma_f32_32x32x16_bf16 v[64:79], v[180:183], v[188:191], v[64:79]
    s_mov_b32 s25, 12288
    buffer_load_dwordx4 v[176:179], v3, s[12:15], s25 offen offset:2048
    buffer_load_dwordx4 v[180:183], v4, s[12:15], s25 offen offset:2048
    buffer_load_dwordx4 v[184:187], v3, s[8:11], s25 offen offset:2048
    buffer_load_dwordx4 v[188:191], v4, s[8:11], s25 offen offset:2048
    s_waitcnt vmcnt(28)
    v_mfma_f32_32x32x16_bf16 v[16:31], v[192:195], v[200:203], v[16:31]
    v_mfma_f32_32x32x16_bf16 v[32:47], v[196:199], v[200:203], v[32:47]
    v_mfma_f32_32x32x16_bf16 v[48:63], v[192:195], v[204:207], v[48:63]
    v_mfma_f32_32x32x16_bf16 v[64:79], v[196:199], v[204:207], v[64:79]
    s_mov_b32 s25, 12288
    buffer_load_dwordx4 v[192:195], v3, s[12:15], s25 offen offset:3072
    buffer_load_dwordx4 v[196:199], v4, s[12:15], s25 offen offset:3072
    buffer_load_dwordx4 v[200:203], v3, s[8:11], s25 offen offset:3072
    buffer_load_dwordx4 v[204:207], v4, s[8:11], s25 offen offset:3072
    s_waitcnt vmcnt(28)
    v_mfma_f32_32x32x16_bf16 v[16:31], v[80:83], v[88:91], v[16:31]
    v_mfma_f32_32x32x16_bf16 v[32:47], v[84:87], v[88:91], v[32:47]
    v_mfma_f32_32x32x16_bf16 v[48:63], v[80:83], v[92:95], v[48:63]
    v_mfma_f32_32x32x16_bf16 v[64:79], v[84:87], v[92:95], v[64:79]
    s_mov_b32 s25, 16384
    buffer_load_dwordx4 v[80:83], v3, s[12:15], s25 offen offset:0
    buffer_load_dwordx4 v[84:87], v4, s[12:15], s25 offen offset:0
    buffer_load_dwordx4 v[88:91], v3, s[8:11], s25 offen offset:0
    buffer_load_dwordx4 v[92:95], v4, s[8:11], s25 offen offset:0
    s_waitcnt vmcnt(28)
    v_mfma_f32_32x32x16_bf16 v[16:31], v[96:99], v[104:107], v[16:31]
    v_mfma_f32_32x32x16_bf16 v[32:47], v[100:103], v[104:107], v[32:47]
    v_mfma_f32_32x32x16_bf16 v[48:63], v[96:99], v[108:111], v[48:63]
    v_mfma_f32_32x32x16_bf16 v[64:79], v[100:103], v[108:111], v[64:79]
    s_mov_b32 s25, 16384
    buffer_load_dwordx4 v[96:99], v3, s[12:15], s25 offen offset:1024
    buffer_load_dwordx4 v[100:103], v4, s[12:15], s25 offen offset:1024
    buffer_load_dwordx4 v[104:107], v3, s[8:11], s25 offen offset:1024
    buffer_load_dwordx4 v[108:111], v4, s[8:11], s25 offen offset:1024
    s_waitcnt vmcnt(28)
    v_mfma_f32_32x32x16_bf16 v[16:31], v[112:115], v[120:123], v[16:31]
    v_mfma_f32_32x32x16_bf16 v[32:47], v[116:119], v[120:123], v[32:47]
    v_mfma_f32_32x32x16_bf16 v[48:63], v[112:115], v[124:127], v[48:63]
    v_mfma_f32_32x32x16_bf16 v[64:79], v[116:119], v[124:127], v[64:79]
    s_mov_b32 s25, 16384
    buffer_load_dwordx4 v[112:115], v3, s[12:15], s25 offen offset:2048
    buffer_load_dwordx4 v[116:119], v4, s[12:15], s25 offen offset:2048
    buffer_load_dwordx4 v[120:123], v3, s[8:11], s25 offen offset:2048
    buffer_load_dwordx4 v[124:127], v4, s[8:11], s25 offen offset:2048
    s_waitcnt vmcnt(28)
    v_mfma_f32_32x32x16_bf16 v[16:31], v[128:131], v[136:139], v[16:31]
    v_mfma_f32_32x32x16_bf16 v[32:47], v[132:135], v[136:139], v[32:47]
    v_mfma_f32_32x32x16_bf16 v[48:63], v[128:131], v[140:143], v[48:63]
    v_mfma_f32_32x32x16_bf16 v[64:79], v[132:135], v[140:143], v[64:79]
    s_mov_b32 s25, 16384
    buffer_load_dwordx4 v[128:131], v3, s[12:15], s25 offen offset:3072
    buffer_load_dwordx4 v[132:135], v4, s[12:15], s25 offen offset:3072
    buffer_load_dwordx4 v[136:139], v3, s[8:11], s25 offen offset:3072
    buffer_load_dwordx4 v[140:143], v4, s[8:11], s25 offen offset:3072
    s_waitcnt vmcnt(28)
    v_mfma_f32_32x32x16_bf16 v[16:31], v[144:147], v[152:155], v[16:31]
    v_mfma_f32_32x32x16_bf16 v[32:47], v[148:151], v[152:155], v[32:47]
    v_mfma_f32_32x32x16_bf16 v[48:63], v[144:147], v[156:159], v[48:63]
    v_mfma_f32_32x32x16_bf16 v[64:79], v[148:151], v[156:159], v[64:79]
    s_mov_b32 s25, 20480
    buffer_load_dwordx4 v[144:147], v3, s[12:15], s25 offen offset:0
    buffer_load_dwordx4 v[148:151], v4, s[12:15], s25 offen offset:0
    buffer_load_dwordx4 v[152:155], v3, s[8:11], s25 offen offset:0
    buffer_load_dwordx4 v[156:159], v4, s[8:11], s25 offen offset:0
    s_waitcnt vmcnt(28)
    v_mfma_f32_32x32x16_bf16 v[16:31], v[160:163], v[168:171], v[16:31]
    v_mfma_f32_32x32x16_bf16 v[32:47], v[164:167], v[168:171], v[32:47]
    v_mfma_f32_32x32x16_bf16 v[48:63], v[160:163], v[172:175], v[48:63]
    v_mfma_f32_32x32x16_bf16 v[64:79], v[164:167], v[172:175], v[64:79]
    s_mov_b32 s25, 20480
    buffer_load_dwordx4 v[160:163], v3, s[12:15], s25 offen offset:1024
    buffer_load_dwordx4 v[164:167], v4, s[12:15], s25 offen offset:1024
    buffer_load_dwordx4 v[168:171], v3, s[8:11], s25 offen offset:1024
    buffer_load_dwordx4 v[172:175], v4, s[8:11], s25 offen offset:1024
    s_waitcnt vmcnt(28)
    v_mfma_f32_32x32x16_bf16 v[16:31], v[176:179], v[184:187], v[16:31]
    v_mfma_f32_32x32x16_bf16 v[32:47], v[180:183], v[184:187], v[32:47]
    v_mfma_f32_32x32x16_bf16 v[48:63], v[176:179], v[188:191], v[48:63]
    v_mfma_f32_32x32x16_bf16 v[64:79], v[180:183], v[188:191], v[64:79]
    s_mov_b32 s25, 20480
    buffer_load_dwordx4 v[176:179], v3, s[12:15], s25 offen offset:2048
    buffer_load_dwordx4 v[180:183], v4, s[12:15], s25 offen offset:2048
    buffer_load_dwordx4 v[184:187], v3, s[8:11], s25 offen offset:2048
    buffer_load_dwordx4 v[188:191], v4, s[8:11], s25 offen offset:2048
    s_waitcnt vmcnt(28)
    v_mfma_f32_32x32x16_bf16 v[16:31], v[192:195], v[200:203], v[16:31]
    v_mfma_f32_32x32x16_bf16 v[32:47], v[196:199], v[200:203], v[32:47]
    v_mfma_f32_32x32x16_bf16 v[48:63], v[192:195], v[204:207], v[48:63]
    v_mfma_f32_32x32x16_bf16 v[64:79], v[196:199], v[204:207], v[64:79]
    s_mov_b32 s25, 20480
    buffer_load_dwordx4 v[192:195], v3, s[12:15], s25 offen offset:3072
    buffer_load_dwordx4 v[196:199], v4, s[12:15], s25 offen offset:3072
    buffer_load_dwordx4 v[200:203], v3, s[8:11], s25 offen offset:3072
    buffer_load_dwordx4 v[204:207], v4, s[8:11], s25 offen offset:3072
    s_waitcnt vmcnt(28)
    v_mfma_f32_32x32x16_bf16 v[16:31], v[80:83], v[88:91], v[16:31]
    v_mfma_f32_32x32x16_bf16 v[32:47], v[84:87], v[88:91], v[32:47]
    v_mfma_f32_32x32x16_bf16 v[48:63], v[80:83], v[92:95], v[48:63]
    v_mfma_f32_32x32x16_bf16 v[64:79], v[84:87], v[92:95], v[64:79]
    s_mov_b32 s25, 24576
    buffer_load_dwordx4 v[80:83], v3, s[12:15], s25 offen offset:0
    buffer_load_dwordx4 v[84:87], v4, s[12:15], s25 offen offset:0
    buffer_load_dwordx4 v[88:91], v3, s[8:11], s25 offen offset:0
    buffer_load_dwordx4 v[92:95], v4, s[8:11], s25 offen offset:0
    s_waitcnt vmcnt(28)
    v_mfma_f32_32x32x16_bf16 v[16:31], v[96:99], v[104:107], v[16:31]
    v_mfma_f32_32x32x16_bf16 v[32:47], v[100:103], v[104:107], v[32:47]
    v_mfma_f32_32x32x16_bf16 v[48:63], v[96:99], v[108:111], v[48:63]
    v_mfma_f32_32x32x16_bf16 v[64:79], v[100:103], v[108:111], v[64:79]
    s_mov_b32 s25, 24576
    buffer_load_dwordx4 v[96:99], v3, s[12:15], s25 offen offset:1024
    buffer_load_dwordx4 v[100:103], v4, s[12:15], s25 offen offset:1024
    buffer_load_dwordx4 v[104:107], v3, s[8:11], s25 offen offset:1024
    buffer_load_dwordx4 v[108:111], v4, s[8:11], s25 offen offset:1024
    s_waitcnt vmcnt(28)
    v_mfma_f32_32x32x16_bf16 v[16:31], v[112:115], v[120:123], v[16:31]
    v_mfma_f32_32x32x16_bf16 v[32:47], v[116:119], v[120:123], v[32:47]
    v_mfma_f32_32x32x16_bf16 v[48:63], v[112:115], v[124:127], v[48:63]
    v_mfma_f32_32x32x16_bf16 v[64:79], v[116:119], v[124:127], v[64:79]
    s_mov_b32 s25, 24576
    buffer_load_dwordx4 v[112:115], v3, s[12:15], s25 offen offset:2048
    buffer_load_dwordx4 v[116:119], v4, s[12:15], s25 offen offset:2048
    buffer_load_dwordx4 v[120:123], v3, s[8:11], s25 offen offset:2048
    buffer_load_dwordx4 v[124:127], v4, s[8:11], s25 offen offset:2048
    s_waitcnt vmcnt(28)
    v_mfma_f32_32x32x16_bf16 v[16:31], v[128:131], v[136:139], v[16:31]
    v_mfma_f32_32x32x16_bf16 v[32:47], v[132:135], v[136:139], v[32:47]
    v_mfma_f32_32x32x16_bf16 v[48:63], v[128:131], v[140:143], v[48:63]
    v_mfma_f32_32x32x16_bf16 v[64:79], v[132:135], v[140:143], v[64:79]
    s_mov_b32 s25, 24576
    buffer_load_dwordx4 v[128:131], v3, s[12:15], s25 offen offset:3072
    buffer_load_dwordx4 v[132:135], v4, s[12:15], s25 offen offset:3072
    buffer_load_dwordx4 v[136:139], v3, s[8:11], s25 offen offset:3072
    buffer_load_dwordx4 v[140:143], v4, s[8:11], s25 offen offset:3072
    s_waitcnt vmcnt(28)
    v_mfma_f32_32x32x16_bf16 v[16:31], v[144:147], v[152:155], v[16:31]
    v_mfma_f32_32x32x16_bf16 v[32:47], v[148:151], v[152:155], v[32:47]
    v_mfma_f32_32x32x16_bf16 v[48:63], v[144:147], v[156:159], v[48:63]
    v_mfma_f32_32x32x16_bf16 v[64:79], v[148:151], v[156:159], v[64:79]
    s_mov_b32 s25, 28672
    buffer_load_dwordx4 v[144:147], v3, s[12:15], s25 offen offset:0
    buffer_load_dwordx4 v[148:151], v4, s[12:15], s25 offen offset:0
    buffer_load_dwordx4 v[152:155], v3, s[8:11], s25 offen offset:0
    buffer_load_dwordx4 v[156:159], v4, s[8:11], s25 offen offset:0
    s_waitcnt vmcnt(28)
    v_mfma_f32_32x32x16_bf16 v[16:31], v[160:163], v[168:171], v[16:31]
    v_mfma_f32_32x32x16_bf16 v[32:47], v[164:167], v[168:171], v[32:47]
    v_mfma_f32_32x32x16_bf16 v[48:63], v[160:163], v[172:175], v[48:63]
    v_mfma_f32_32x32x16_bf16 v[64:79], v[164:167], v[172:175], v[64:79]
    s_mov_b32 s25, 28672
    buffer_load_dwordx4 v[160:163], v3, s[12:15], s25 offen offset:1024
    buffer_load_dwordx4 v[164:167], v4, s[12:15], s25 offen offset:1024
    buffer_load_dwordx4 v[168:171], v3, s[8:11], s25 offen offset:1024
    buffer_load_dwordx4 v[172:175], v4, s[8:11], s25 offen offset:1024
    s_waitcnt vmcnt(28)
    v_mfma_f32_32x32x16_bf16 v[16:31], v[176:179], v[184:187], v[16:31]
    v_mfma_f32_32x32x16_bf16 v[32:47], v[180:183], v[184:187], v[32:47]
    v_mfma_f32_32x32x16_bf16 v[48:63], v[176:179], v[188:191], v[48:63]
    v_mfma_f32_32x32x16_bf16 v[64:79], v[180:183], v[188:191], v[64:79]
    s_mov_b32 s25, 28672
    buffer_load_dwordx4 v[176:179], v3, s[12:15], s25 offen offset:2048
    buffer_load_dwordx4 v[180:183], v4, s[12:15], s25 offen offset:2048
    buffer_load_dwordx4 v[184:187], v3, s[8:11], s25 offen offset:2048
    buffer_load_dwordx4 v[188:191], v4, s[8:11], s25 offen offset:2048
    s_waitcnt vmcnt(28)
    v_mfma_f32_32x32x16_bf16 v[16:31], v[192:195], v[200:203], v[16:31]
    v_mfma_f32_32x32x16_bf16 v[32:47], v[196:199], v[200:203], v[32:47]
    v_mfma_f32_32x32x16_bf16 v[48:63], v[192:195], v[204:207], v[48:63]
    v_mfma_f32_32x32x16_bf16 v[64:79], v[196:199], v[204:207], v[64:79]
    s_mov_b32 s25, 28672
    buffer_load_dwordx4 v[192:195], v3, s[12:15], s25 offen offset:3072
    buffer_load_dwordx4 v[196:199], v4, s[12:15], s25 offen offset:3072
    buffer_load_dwordx4 v[200:203], v3, s[8:11], s25 offen offset:3072
    buffer_load_dwordx4 v[204:207], v4, s[8:11], s25 offen offset:3072
    s_waitcnt vmcnt(28)
    v_mfma_f32_32x32x16_bf16 v[16:31], v[80:83], v[88:91], v[16:31]
    v_mfma_f32_32x32x16_bf16 v[32:47], v[84:87], v[88:91], v[32:47]
    v_mfma_f32_32x32x16_bf16 v[48:63], v[80:83], v[92:95], v[48:63]
    v_mfma_f32_32x32x16_bf16 v[64:79], v[84:87], v[92:95], v[64:79]
    s_waitcnt vmcnt(24)
    v_mfma_f32_32x32x16_bf16 v[16:31], v[96:99], v[104:107], v[16:31]
    v_mfma_f32_32x32x16_bf16 v[32:47], v[100:103], v[104:107], v[32:47]
    v_mfma_f32_32x32x16_bf16 v[48:63], v[96:99], v[108:111], v[48:63]
    v_mfma_f32_32x32x16_bf16 v[64:79], v[100:103], v[108:111], v[64:79]
    s_waitcnt vmcnt(20)
    v_mfma_f32_32x32x16_bf16 v[16:31], v[112:115], v[120:123], v[16:31]
    v_mfma_f32_32x32x16_bf16 v[32:47], v[116:119], v[120:123], v[32:47]
    v_mfma_f32_32x32x16_bf16 v[48:63], v[112:115], v[124:127], v[48:63]
    v_mfma_f32_32x32x16_bf16 v[64:79], v[116:119], v[124:127], v[64:79]
    s_waitcnt vmcnt(16)
    v_mfma_f32_32x32x16_bf16 v[16:31], v[128:131], v[136:139], v[16:31]
    v_mfma_f32_32x32x16_bf16 v[32:47], v[132:135], v[136:139], v[32:47]
    v_mfma_f32_32x32x16_bf16 v[48:63], v[128:131], v[140:143], v[48:63]
    v_mfma_f32_32x32x16_bf16 v[64:79], v[132:135], v[140:143], v[64:79]
    s_waitcnt vmcnt(12)
    v_mfma_f32_32x32x16_bf16 v[16:31], v[144:147], v[152:155], v[16:31]
    v_mfma_f32_32x32x16_bf16 v[32:47], v[148:151], v[152:155], v[32:47]
    v_mfma_f32_32x32x16_bf16 v[48:63], v[144:147], v[156:159], v[48:63]
    v_mfma_f32_32x32x16_bf16 v[64:79], v[148:151], v[156:159], v[64:79]
    s_waitcnt vmcnt(8)
    v_mfma_f32_32x32x16_bf16 v[16:31], v[160:163], v[168:171], v[16:31]
    v_mfma_f32_32x32x16_bf16 v[32:47], v[164:167], v[168:171], v[32:47]
    v_mfma_f32_32x32x16_bf16 v[48:63], v[160:163], v[172:175], v[48:63]
    v_mfma_f32_32x32x16_bf16 v[64:79], v[164:167], v[172:175], v[64:79]
    s_waitcnt vmcnt(4)
    v_mfma_f32_32x32x16_bf16 v[16:31], v[176:179], v[184:187], v[16:31]
    v_mfma_f32_32x32x16_bf16 v[32:47], v[180:183], v[184:187], v[32:47]
    v_mfma_f32_32x32x16_bf16 v[48:63], v[176:179], v[188:191], v[48:63]
    v_mfma_f32_32x32x16_bf16 v[64:79], v[180:183], v[188:191], v[64:79]
    s_waitcnt vmcnt(0)
    v_mfma_f32_32x32x16_bf16 v[16:31], v[192:195], v[200:203], v[16:31]
    v_mfma_f32_32x32x16_bf16 v[32:47], v[196:199], v[200:203], v[32:47]
    v_mfma_f32_32x32x16_bf16 v[48:63], v[192:195], v[204:207], v[48:63]
    v_mfma_f32_32x32x16_bf16 v[64:79], v[196:199], v[204:207], v[64:79]
    s_nop 15
    s_lshl_b32 s23, s20, 14
    v_lshlrev_b32 v5, 4, v2
    v_add_u32 v6, s23, v5
    ds_write_b128 v6, v[16:19] offset:0
    ds_write_b128 v6, v[20:23] offset:1024
    ds_write_b128 v6, v[24:27] offset:2048
    ds_write_b128 v6, v[28:31] offset:3072
    ds_write_b128 v6, v[32:35] offset:4096
    ds_write_b128 v6, v[36:39] offset:5120
    ds_write_b128 v6, v[40:43] offset:6144
    ds_write_b128 v6, v[44:47] offset:7168
    ds_write_b128 v6, v[48:51] offset:8192
    ds_write_b128 v6, v[52:55] offset:9216
    ds_write_b128 v6, v[56:59] offset:10240
    ds_write_b128 v6, v[60:63] offset:11264
    ds_write_b128 v6, v[64:67] offset:12288
    ds_write_b128 v6, v[68:71] offset:13312
    ds_write_b128 v6, v[72:75] offset:14336
    ds_write_b128 v6, v[76:79] offset:15360
    s_waitcnt lgkmcnt(0)
    s_barrier
    s_lshl_b32 s23, s20, 11
    v_add_u32 v6, s23, v5
    v_add_u32 v7, 0x10000, v6
    ds_read_b128 v[80:83], v6 offset:0
    ds_read_b128 v[84:87], v6 offset:1024
    ds_read_b128 v[88:91], v6 offset:16384
    ds_read_b128 v[92:95], v6 offset:17408
    ds_read_b128 v[96:99], v6 offset:32768
    ds_read_b128 v[100:103], v6 offset:33792
    ds_read_b128 v[104:107], v6 offset:49152
    ds_read_b128 v[108:111], v6 offset:50176
    ds_read_b128 v[112:115], v7 offset:0
    ds_read_b128 v[116:119], v7 offset:1024
    ds_read_b128 v[120:123], v7 offset:16384
    ds_read_b128 v[124:127], v7 offset:17408
    ds_read_b128 v[128:131], v7 offset:32768
    ds_read_b128 v[132:135], v7 offset:33792
    ds_read_b128 v[136:139], v7 offset:49152
    ds_read_b128 v[140:143], v7 offset:50176
    s_waitcnt lgkmcnt(0)
    v_add_f32 v80, v80, v88
    v_add_f32 v80, v80, v96
    v_add_f32 v80, v80, v104
    v_add_f32 v80, v80, v112
    v_add_f32 v80, v80, v120
    v_add_f32 v80, v80, v128
    v_add_f32 v80, v80, v136
    v_add_f32 v81, v81, v89
    v_add_f32 v81, v81, v97
    v_add_f32 v81, v81, v105
    v_add_f32 v81, v81, v113
    v_add_f32 v81, v81, v121
    v_add_f32 v81, v81, v129
    v_add_f32 v81, v81, v137
    v_add_f32 v82, v82, v90
    v_add_f32 v82, v82, v98
    v_add_f32 v82, v82, v106
    v_add_f32 v82, v82, v114
    v_add_f32 v82, v82, v122
    v_add_f32 v82, v82, v130
    v_add_f32 v82, v82, v138
    v_add_f32 v83, v83, v91
    v_add_f32 v83, v83, v99
    v_add_f32 v83, v83, v107
    v_add_f32 v83, v83, v115
    v_add_f32 v83, v83, v123
    v_add_f32 v83, v83, v131
    v_add_f32 v83, v83, v139
    v_add_f32 v84, v84, v92
    v_add_f32 v84, v84, v100
    v_add_f32 v84, v84, v108
    v_add_f32 v84, v84, v116
    v_add_f32 v84, v84, v124
    v_add_f32 v84, v84, v132
    v_add_f32 v84, v84, v140
    v_add_f32 v85, v85, v93
    v_add_f32 v85, v85, v101
    v_add_f32 v85, v85, v109
    v_add_f32 v85, v85, v117
    v_add_f32 v85, v85, v125
    v_add_f32 v85, v85, v133
    v_add_f32 v85, v85, v141
    v_add_f32 v86, v86, v94
    v_add_f32 v86, v86, v102
    v_add_f32 v86, v86, v110
    v_add_f32 v86, v86, v118
    v_add_f32 v86, v86, v126
    v_add_f32 v86, v86, v134
    v_add_f32 v86, v86, v142
    v_add_f32 v87, v87, v95
    v_add_f32 v87, v87, v103
    v_add_f32 v87, v87, v111
    v_add_f32 v87, v87, v119
    v_add_f32 v87, v87, v127
    v_add_f32 v87, v87, v135
    v_add_f32 v87, v87, v143
    v_cvt_pk_bf16_f32 v16, v80, v81
    v_cvt_pk_bf16_f32 v17, v82, v83
    v_cvt_pk_bf16_f32 v18, v84, v85
    v_cvt_pk_bf16_f32 v19, v86, v87
    s_lshr_b32 s23, s20, 2
    s_lshl_b32 s23, s23, 15
    s_and_b32 s24, s20, 3
    s_lshl_b32 s24, s24, 5
    s_add_u32 s23, s23, s24
    v_and_b32 v8, 31, v2
    v_lshlrev_b32 v8, 10, v8
    v_lshrrev_b32 v9, 5, v2
    v_lshl_add_u32 v8, v9, 3, v8
    v_add_u32 v8, s23, v8
    buffer_store_dwordx2 v[16:17], v8, s[16:19], 0 offen
    buffer_store_dwordx2 v[18:19], v8, s[16:19], 0 offen offset:16
L2_done:
    s_endpgm
.section .rodata,"a"
.p2align 6
.amdhsa_kernel attn_kernel
  .amdhsa_next_free_vgpr 256
  .amdhsa_next_free_sgpr 64
  .amdhsa_accum_offset 256
  .amdhsa_group_segment_fixed_size 0
  .amdhsa_kernarg_size 64
  .amdhsa_user_sgpr_count 2
  .amdhsa_user_sgpr_kernarg_segment_ptr 1
  .amdhsa_system_sgpr_workgroup_id_x 1
.end_amdhsa_kernel
.p2align 6
.amdhsa_kernel standalone__mha_block_cached__near_ridge_kernel
  .amdhsa_next_free_vgpr 208
  .amdhsa_next_free_sgpr 32
  .amdhsa_accum_offset 208
  .amdhsa_group_segment_fixed_size 0
  .amdhsa_kernarg_size 64
  .amdhsa_user_sgpr_count 2
  .amdhsa_user_sgpr_kernarg_segment_ptr 1
  .amdhsa_system_sgpr_workgroup_id_x 1
.end_amdhsa_kernel
```
